```python
import torch

def _softmax(x, axis=-1):
    return torch.softmax(x, dim=axis)
def _gelu(x):
    return torch.nn.functional.gelu(x, approximate="tanh")
def _silu(x):
    return torch.nn.functional.silu(x)
def _sigmoid(x):
    return torch.sigmoid(x)
def _layernorm(x, axis=-1, eps=1e-5):
    m = x.mean(dim=axis, keepdim=True)
    v = x.var(dim=axis, keepdim=True, unbiased=False)
    return (x - m) / torch.sqrt(v + eps)
def _scatter_add(tgt, idx, src, axis=0):
    return tgt.clone().index_add_(axis, idx, src)
def _segment_sum(src, seg, n):
    out = torch.zeros((n,) + src.shape[1:], dtype=src.dtype)
    return out.index_add_(0, seg, src)
def _pad(x, pw):
    flat = tuple(v for pair in reversed(pw) for v in pair)
    return torch.nn.functional.pad(x, flat)

kernel_name = 'gated_mix__ssm_conv_s4__mixer_channel_mlp__prompt'

def setup_inputs():

    _w = (lambda a: (lambda t: t.to(torch.bfloat16) if t.is_floating_point() else t)(torch.as_tensor(a)))
    def _A_setup():
        B, L, D, N = 1, 2048, 512, 128
        A_re = -(lambda _x: torch.exp(torch.as_tensor(_x)))((lambda *s: torch.randn(*s, dtype=torch.bfloat16) * 3.2)(D, N))
        A_im = torch.pi * (lambda *s: torch.randn(*s, dtype=torch.bfloat16) * 0.1)(D, N)
        B_re = (lambda *s: torch.randn(*s, dtype=torch.bfloat16) * 0.2)(D, N)
        B_im = (lambda *s: torch.randn(*s, dtype=torch.bfloat16) * 0.2)(D, N)
        C_re = (lambda *s: torch.randn(*s, dtype=torch.bfloat16) * 0.2)(D, N)
        C_im = (lambda *s: torch.randn(*s, dtype=torch.bfloat16) * 0.2)(D, N)
        log_dt = (lambda *s: torch.randn(*s, dtype=torch.bfloat16) * 0.1)(D) * 0.5 - 4.0
        Dskip = (lambda *s: torch.randn(*s, dtype=torch.bfloat16) * 0.1)(D)
        return {
            "u": _w((lambda *s: torch.randn(*s, dtype=torch.bfloat16) * 0.05)(B, L, D)),
            "A_re": _w(A_re),
            "A_im": _w(A_im),
            "B_re": _w(B_re),
            "B_im": _w(B_im),
            "C_re": _w(C_re),
            "C_im": _w(C_im),
            "log_dt": _w(log_dt),
            "Dskip": _w(Dskip),
        }
    _A_in = _A_setup()

    def _B_setup():
        B, S, D, F = 1, 2048, 512, 1792
        return {
            "x": _w((lambda *s: torch.randn(*s, dtype=torch.bfloat16) * 0.05)(B, S, D)),
            "w1": _w((lambda *s: torch.randn(*s, dtype=torch.bfloat16) * 0.8)(D, F) * (D ** -0.5)),
            "b1": _w((lambda *s: torch.randn(*s, dtype=torch.bfloat16) * 0.2)(F)),
            "w2": _w((lambda *s: torch.randn(*s, dtype=torch.bfloat16) * 0.05)(F, D) * (F ** -0.5)),
            "b2": _w((lambda *s: torch.randn(*s, dtype=torch.bfloat16) * 0.05)(D)),
        }
    _B_in = _B_setup()

    return {
        "A_u": _A_in["u"],
        "A_A_re": _A_in["A_re"],
        "A_A_im": _A_in["A_im"],
        "A_B_re": _A_in["B_re"],
        "A_B_im": _A_in["B_im"],
        "A_C_re": _A_in["C_re"],
        "A_C_im": _A_in["C_im"],
        "A_log_dt": _A_in["log_dt"],
        "A_Dskip": _A_in["Dskip"],
        "B_x": _B_in["x"],
        "B_w1": _B_in["w1"],
        "B_b1": _B_in["b1"],
        "B_w2": _B_in["w2"],
        "B_b2": _B_in["b2"],
        "gate_w": _w((lambda *s: torch.randn(*s, dtype=torch.bfloat16) * 0.05)(512) * 16.0),
    }

def reference(A_u, A_A_re, A_A_im, A_B_re, A_B_im, A_C_re, A_C_im, A_log_dt, A_Dskip, B_x, B_w1, B_b1, B_w2, B_b2, gate_w):
    def _A_ref(u, A_re, A_im, B_re, B_im, C_re, C_im, log_dt, Dskip):
        Bsz, L, D = u.shape
        dt = torch.exp(log_dt)[:, None]
        A = A_re + 1j * A_im
        Bc = B_re + 1j * B_im
        Cc = C_re + 1j * C_im
        logdA = dt * A
        dB = dt * Bc
        l = (lambda x, dt: x.to(dt))(torch.arange(L), A_re.dtype)
        P = torch.exp(logdA[:, :, None] * l[None, None, :])
        K = torch.einsum("dn,dnl,dn->dl", Cc, P, dB).real
        L2 = 2 * L
        Kp = _pad(K, ((0, 0), (0, L)))
        up = (lambda x, *d: x.permute(*d))(u, 0, 2, 1)
        up = _pad(up, ((0, 0), (0, 0), (0, L)))
        Kf = (lambda x, axes=(-2,-1): torch.fft.rfft2(x.float(), dim=axes))(Kp[:, None, :], axes=(-2, -1))
        Uf = (lambda x, axes=(-2,-1): torch.fft.rfft2(x.float(), dim=axes))(up[:, :, None, :], axes=(-2, -1))
        Yf = Uf * Kf[None, :, :, :]
        y = (lambda x, s, axes=(-2,-1): torch.fft.irfft2(x, s=s, dim=axes).to(torch.bfloat16))(Yf, (1, L2), axes=(-2, -1))[:, :, 0, :L]
        y = (lambda x, *d: x.permute(*d))(y, 0, 2, 1) + u * Dskip[None, None, :]
        return y

    def _B_ref(x, w1, b1, w2, b2):
        y = _layernorm(x, axis=-1)
        h = _gelu(torch.einsum("bsd,df->bsf", y, w1) + b1)
        return torch.einsum("bsf,fd->bsd", h, w2) + b2

    x = A_u
    g = _sigmoid((x * gate_w).sum(-1, keepdims=True))
    a = _A_ref(x, A_A_re, A_A_im, A_B_re, A_B_im, A_C_re, A_C_im, A_log_dt, A_Dskip)
    b = _B_ref(x, B_w1, B_b1, B_w2, B_b2)
    return g * a + (1 - g) * b
```

```asm
; @launch grid=(256,1,1) block=(256,1,1) lds=163840
.amdgcn_target "amdgcn-amd-amdhsa--gfx950"
.set PF_LINES, 6
.text
.globl gated_mix__ssm_conv_s4__mixer_channel_mlp__prompt_kernel
.p2align 8
.type gated_mix__ssm_conv_s4__mixer_channel_mlp__prompt_kernel,@function
gated_mix__ssm_conv_s4__mixer_channel_mlp__prompt_kernel:
  s_cmp_ge_u32 s2, 256
  s_cbranch_scc1 L_end
  s_load_dwordx16 s[32:47], s[0:1], 0
  s_load_dwordx2 s[48:49], s[0:1], 64
  s_load_dwordx4 s[52:55], s[0:1], 80
  s_load_dwordx4 s[56:59], s[0:1], 96
  s_load_dwordx4 s[60:63], s[0:1], 112
  s_load_dwordx4 s[64:67], s[0:1], 128
  v_lshrrev_b32 v4, 6, v0
  v_and_b32 v1, 63, v0
  v_readfirstlane_b32 s4, v4
  v_and_b32 v2, 15, v1
  v_lshrrev_b32 v3, 4, v1
  s_and_b32 s3, s2, 7
  s_lshr_b32 s73, s2, 3
  s_and_b32 s10, s73, 3
  s_lshr_b32 s9, s73, 2
  s_lshr_b32 s11, s3, 1
  s_lshl_b32 s11, s11, 2
  s_add_u32 s5, s11, s10
  s_and_b32 s11, s3, 1
  s_lshl_b32 s11, s11, 3
  s_add_u32 s6, s11, s9
  s_lshl_b32 s11, s3, 2
  s_add_u32 s8, s11, s10
  s_getpc_b64 s[84:85]
L_pc:
  s_lshl_b32 s3, s73, 2
  s_add_u32 s3, s3, s4
  s_mul_i32 s3, s3, PF_LINES
  v_min_u32 v251, PF_LINES-1, v1
  v_add_lshl_u32 v251, v251, s3, 6
  v_min_u32 v251, L_gend-L_pc-4, v251
  global_load_dword v252, v251, s[84:85]
  v_and_b32 v185, 7, v1
  v_xor_b32 v185, v185, v3
  v_lshrrev_b32 v186, 3, v1
  v_lshlrev_b32 v186, 10, v186
  v_lshl_add_u32 v172, v185, 4, v186
  v_xor_b32 v184, 64, v172
  v_add_u32 v173, 7168, v184
  v_add_u32 v174, 14336, v172
  v_add_u32 v175, 21504, v184
  s_and_b32 s3, s4, 1
  s_lshl_b32 s3, s3, 2
  v_or_b32 v184, s3, v3
  v_lshrrev_b32 v185, 1, v2
  v_xor_b32 v185, v185, v184
  v_min_u32 v185, 6, v185
  v_lshlrev_b32 v185, 5, v185
  v_and_b32 v186, 1, v2
  v_lshl_add_u32 v185, v186, 4, v185
  v_mul_u32_u24 v176, 3584, v3
  v_add_u32 v176, v176, v185
  v_add_u32 v177, 13312, v176
  v_lshlrev_b32 v250, 4, v1
  s_lshl_b32 s68, s5, 2
  s_add_u32 s68, s68, s4
  s_lshl_b32 s68, s68, 15
  s_mul_i32 s70, s4, 28672
  s_mul_i32 s3, s6, 224
  s_add_u32 s70, s70, s3
  s_lshl_b32 s71, s4, 12
  s_lshl_b32 s96, s4, 11
  s_add_u32 s96, s96, 0x10000
  s_add_u32 s93, s5, s6
  s_waitcnt lgkmcnt(0)
  s_mov_b32 s12, s32
  s_and_b32 s13, s33, 0xffff
  s_mov_b32 s14, 2097152
  s_mov_b32 s15, 0x20000
  s_mov_b32 s16, s52
  s_and_b32 s17, s53, 0xffff
  s_mov_b32 s18, 1835008
  s_mov_b32 s19, 0x20000
  s_add_u32 s94, s93, 0
  s_and_b32 s94, s94, 7
  s_lshl_b32 s94, s94, 7
  s_add_u32 s94, s94, s68
  s_add_u32 m0, s71, 0
  s_nop 0
  buffer_load_dwordx4 v172, s[12:15], s94 offen offset:0 lds
  buffer_load_dwordx4 v173, s[12:15], s94 offen offset:1024 lds
  s_add_u32 m0, s71, 0
  s_nop 0
  buffer_load_dwordx4 v174, s[12:15], s94 offen offset:2048 lds
  buffer_load_dwordx4 v175, s[12:15], s94 offen offset:3072 lds
  s_add_u32 s95, s93, 0
  s_and_b32 s95, s95, 7
  s_mul_i32 s95, s95, 229376
  s_add_u32 s95, s95, s70
  s_add_u32 m0, s96, 0
  s_nop 0
  buffer_load_dwordx4 v176, s[16:19], s95 offen offset:0 lds
  buffer_load_dwordx4 v177, s[16:19], s95 offen offset:1024 lds
  s_mov_b32 m0, 131072
  s_nop 0
  global_load_lds_dwordx4 v250, s[60:61]
  s_add_u32 s95, s95, 114688
  s_add_u32 m0, s96, 8192
  s_nop 0
  buffer_load_dwordx4 v176, s[16:19], s95 offen offset:0 lds
  buffer_load_dwordx4 v177, s[16:19], s95 offen offset:1024 lds
  s_lshr_b32 s3, s4, 1
  s_lshl_b32 s10, s2, 1
  s_add_u32 s10, s10, s3
  s_and_b32 s3, s4, 1
  s_lshl_b32 s3, s3, 6
  s_lshl_b32 s11, s10, 7
  s_add_u32 s11, s11, s3
  v_add_lshl_u32 v253, v1, s11, 1
  s_lshl_b32 s10, s10, 1
  v_mov_b32 v31, s10
  v_and_b32 v187, 127, v0
  v_min_u32 v187, 111, v187
  s_mul_i32 s3, s6, 112
  v_add_lshl_u32 v29, v187, s3, 1
  s_mov_b32 s20, s56
  s_and_b32 s21, s57, 0xffff
  s_mov_b32 s22, 1835008
  s_mov_b32 s23, 0x20000
  s_mov_b32 s24, s66
  s_and_b32 s25, s67, 0xffff
  s_mov_b32 s26, 13500416
  s_mov_b32 s27, 0x20000
  s_mov_b32 s28, s62
  s_and_b32 s29, s63, 0xffff
  s_mov_b32 s30, 2097152
  s_mov_b32 s31, 0x20000
  v_lshrrev_b32 v184, 2, v1
  v_lshlrev_b32 v184, 10, v184
  v_and_b32 v185, 3, v1
  v_lshl_add_u32 v178, v185, 4, v184
  v_mov_b32 v30, 0
  s_lshl_b32 s3, s9, 6
  v_add_lshl_u32 v247, v1, s3, 1
  s_lshl_b32 s86, s2, 2
  s_add_u32 s86, s86, s4
  s_min_u32 s86, s86, 895
  s_mul_i32 s87, s86, 9363
  s_lshr_b32 s87, s87, 18
  s_mul_i32 s3, s87, 28
  s_sub_u32 s88, s86, s3
  s_lshr_b32 s88, s88, 1
  s_cmp_ge_u32 s88, 7
  s_cselect_b32 s3, 1, 0
  s_mul_i32 s10, s3, 7
  s_sub_u32 s10, s88, s10
  s_mul_i32 s3, s3, 224
  s_lshl_b32 s11, s10, 5
  s_cmp_ge_u32 s10, 3
  s_cselect_b32 s7, 16, 0
  s_add_u32 s11, s11, s7
  s_add_u32 s7, s11, 16
  s_cmp_eq_u32 s10, 6
  s_cselect_b32 s11, 96, s11
  s_cselect_b32 s7, 208, s7
  s_add_u32 s11, s11, s3
  s_add_u32 s7, s7, s3
  s_and_b32 s3, s87, 3
  s_mul_i32 s3, s3, 448
  s_add_u32 s11, s11, s3
  s_add_u32 s7, s7, s3
  s_lshl_b32 s11, s11, 10
  s_lshl_b32 s7, s7, 10
  s_lshr_b32 s3, s87, 2
  s_lshl_b32 s3, s3, 7
  s_and_b32 s10, s86, 1
  s_lshl_b32 s10, s10, 6
  s_add_u32 s3, s3, s10
  s_add_u32 s50, s11, s3
  s_add_u32 s51, s7, s3
  s_sub_u32 s51, s51, 1024
  s_lshl_b32 s89, s86, 11
  s_add_u32 s89, s89, 11665408
  s_lshl_b32 s3, s9, 2
  s_add_u32 s3, s3, s4
  s_mul_i32 s97, s3, 57344
  s_add_u32 s97, s97, 11665408
  s_mul_i32 s3, s3, 224
  s_add_u32 s3, s3, 77824
  v_min_u32 v27, 6, v1
  v_lshl_add_u32 v27, v27, 5, s3
  v_lshlrev_b32 v28, 4, v1
  v_mov_b32 v152, 0x3f803f80
  v_mov_b32 v192, 0
  v_mov_b32 v153, 0x3f803f80
  v_mov_b32 v193, 0
  v_mov_b32 v154, 0x3f803f80
  v_mov_b32 v194, 0
  v_mov_b32 v155, 0x3f803f80
  v_mov_b32 v195, 0
  v_lshlrev_b32 v186, 4, v1
  v_add_u32 v196, 131072, v186
  s_lshl_b32 s7, s4, 11
  s_add_u32 m0, s7, 143616
  s_nop 0
  buffer_load_dwordx4 v178, s[20:23], s50 offen lds
  ds_write_b128 v196, v[152:155] offset:1088
  ds_write_b128 v196, v[192:195] offset:2176
  v_lshrrev_b32 v184, 2, v2
  v_and_b32 v185, 1, v3
  v_lshl_or_b32 v185, v185, 2, v184
  v_lshl_add_u32 v186, v3, 3, v184
  v_lshlrev_b32 v186, 8, v186
  v_and_b32 v187, 3, v2
  v_lshl_add_u32 v186, v187, 3, v186
  v_add_u32 v186, 0x10000, v186
  buffer_load_dwordx4 v178, s[20:23], s51 offen offset:1024 lds
  v_xor_b32 v188, 0, v185
  v_lshl_add_u32 v4, v188, 5, v186
  v_xor_b32 v188, 1, v185
  v_lshl_add_u32 v5, v188, 5, v186
  v_xor_b32 v188, 2, v185
  v_lshl_add_u32 v6, v188, 5, v186
  v_xor_b32 v188, 3, v185
  v_lshl_add_u32 v7, v188, 5, v186
  v_xor_b32 v188, 4, v185
  v_lshl_add_u32 v8, v188, 5, v186
  s_add_u32 s94, s93, 1
  s_and_b32 s94, s94, 7
  s_lshl_b32 s94, s94, 7
  s_add_u32 s94, s94, s68
  s_add_u32 m0, s71, 16384
  s_nop 0
  buffer_load_dwordx4 v172, s[12:15], s94 offen offset:0 lds
  v_xor_b32 v188, 5, v185
  v_lshl_add_u32 v9, v188, 5, v186
  v_xor_b32 v188, 6, v185
  v_lshl_add_u32 v10, v188, 5, v186
  s_lshl_b32 s3, s4, 1
  v_xor_b32 v188, s3, v185
  v_lshl_add_u32 v11, v188, 5, v186
  v_xor_b32 v188, s3, v185
  v_xor_b32 v188, 1, v188
  v_lshl_add_u32 v12, v188, 5, v186
  v_or_b32 v184, 0, v3
  v_lshrrev_b32 v190, 1, v2
  v_xor_b32 v184, v184, v190
  v_lshlrev_b32 v190, 7, v2
  v_lshl_add_u32 v184, v184, 4, v190
  v_add_u32 v14, s71, v184
  buffer_load_dwordx4 v173, s[12:15], s94 offen offset:1024 lds
  v_or_b32 v184, 4, v3
  v_lshrrev_b32 v190, 1, v2
  v_xor_b32 v184, v184, v190
  v_lshlrev_b32 v190, 7, v2
  v_lshl_add_u32 v184, v184, 4, v190
  v_add_u32 v15, s71, v184
  v_mov_b32 v13, 133248
  v_mov_b32 v188, 132160
  v_mov_b32 v189, 131072
  v_cmp_eq_u32 vcc, 0, v187
  s_nop 1
  v_cndmask_b32 v13, v13, v188, vcc
  s_add_u32 m0, s71, 16384
  s_nop 0
  buffer_load_dwordx4 v174, s[12:15], s94 offen offset:2048 lds
  v_cmp_eq_u32 vcc, 1, v187
  s_nop 1
  v_cndmask_b32 v13, v13, v189, vcc
  v_lshl_add_u32 v13, v3, 4, v13
  v_lshrrev_b32 v184, 2, v2
  v_lshl_add_u32 v184, v3, 2, v184
  v_lshlrev_b32 v184, 6, v184
  v_and_b32 v185, 3, v2
  v_lshl_add_u32 v184, v185, 3, v184
  s_lshl_b32 s3, s4, 11
  s_add_u32 s3, s3, 143616
  v_add_u32 v190, s3, v184
  buffer_load_dwordx4 v175, s[12:15], s94 offen offset:3072 lds
  s_add_u32 s95, s93, 1
  s_and_b32 s95, s95, 7
  s_mul_i32 s95, s95, 229376
  s_add_u32 s95, s95, s70
  s_add_u32 m0, s96, 16384
  s_nop 0
  buffer_load_dwordx4 v176, s[16:19], s95 offen offset:0 lds
  buffer_load_dwordx4 v177, s[16:19], s95 offen offset:1024 lds
  s_add_u32 s95, s95, 114688
  s_add_u32 m0, s96, 24576
  s_nop 0
  buffer_load_dwordx4 v176, s[16:19], s95 offen offset:0 lds
  buffer_load_dwordx4 v177, s[16:19], s95 offen offset:1024 lds
  s_add_u32 s94, s93, 2
  s_and_b32 s94, s94, 7
  s_lshl_b32 s94, s94, 7
  s_add_u32 s94, s94, s68
  s_add_u32 m0, s71, 32768
  s_nop 0
  buffer_load_dwordx4 v172, s[12:15], s94 offen offset:0 lds
  buffer_load_dwordx4 v173, s[12:15], s94 offen offset:1024 lds
  s_add_u32 m0, s71, 32768
  s_nop 0
  buffer_load_dwordx4 v174, s[12:15], s94 offen offset:2048 lds
  buffer_load_dwordx4 v175, s[12:15], s94 offen offset:3072 lds
  s_add_u32 s95, s93, 2
  s_and_b32 s95, s95, 7
  s_mul_i32 s95, s95, 229376
  s_add_u32 s95, s95, s70
  s_add_u32 m0, s96, 32768
  s_nop 0
  buffer_load_dwordx4 v176, s[16:19], s95 offen offset:0 lds
  buffer_load_dwordx4 v177, s[16:19], s95 offen offset:1024 lds
  s_add_u32 s95, s95, 114688
  s_add_u32 m0, s96, 40960
  s_nop 0
  buffer_load_dwordx4 v176, s[16:19], s95 offen offset:0 lds
  buffer_load_dwordx4 v177, s[16:19], s95 offen offset:1024 lds
  s_add_u32 s7, s93, 0
  s_and_b32 s7, s7, 7
  s_lshl_b32 s7, s7, 7
  v_add_u32 v183, s7, v13
  s_waitcnt vmcnt(20)
  s_waitcnt lgkmcnt(0)
  s_barrier
  ds_read_b128 v[156:159], v14 offset:0
  ds_read_b128 v[160:163], v14 offset:2048
  ds_read_b64_tr_b16 v[112:113], v4 offset:0
  ds_read_b64_tr_b16 v[114:115], v4 offset:1024
  ds_read_b64_tr_b16 v[116:117], v5 offset:0
  ds_read_b64_tr_b16 v[118:119], v5 offset:1024
  ds_read_b64_tr_b16 v[120:121], v6 offset:0
  ds_read_b64_tr_b16 v[122:123], v6 offset:1024
  ds_read_b64_tr_b16 v[124:125], v7 offset:0
  ds_read_b64_tr_b16 v[126:127], v7 offset:1024
  ds_read_b64_tr_b16 v[128:129], v8 offset:0
  ds_read_b64_tr_b16 v[130:131], v8 offset:1024
  ds_read_b64_tr_b16 v[132:133], v9 offset:0
  ds_read_b64_tr_b16 v[134:135], v9 offset:1024
  ds_read_b64_tr_b16 v[136:137], v10 offset:0
  ds_read_b64_tr_b16 v[138:139], v10 offset:1024
  s_waitcnt lgkmcnt(10)
  v_mfma_f32_16x16x32_bf16 v[32:35], v[112:115], v[156:159], 0
  s_add_u32 s94, s93, 3
  s_and_b32 s94, s94, 7
  ds_read_b64_tr_b16 v[140:141], v11 offset:0
  v_mfma_f32_16x16x32_bf16 v[36:39], v[112:115], v[160:163], 0
  s_lshl_b32 s94, s94, 7
  s_add_u32 s94, s94, s68
  ds_read_b64_tr_b16 v[142:143], v11 offset:1024
  v_mfma_f32_16x16x32_bf16 v[40:43], v[116:119], v[156:159], 0
  s_waitcnt vmcnt(18)
  s_add_u32 m0, s71, 49152
  ds_read_b64_tr_b16 v[144:145], v12 offset:0
  v_mfma_f32_16x16x32_bf16 v[44:47], v[116:119], v[160:163], 0
  s_waitcnt vmcnt(16)
  ds_read_b64_tr_b16 v[146:147], v12 offset:1024
  s_waitcnt lgkmcnt(10)
  v_mfma_f32_16x16x32_bf16 v[48:51], v[120:123], v[156:159], 0
  s_barrier
  ds_read_b128 v[148:151], v183 offset:0
  ds_read_b64_tr_b16 v[200:201], v190 offset:0
  v_mfma_f32_16x16x32_bf16 v[52:55], v[120:123], v[160:163], 0
  buffer_load_dwordx4 v172, s[12:15], s94 offen offset:0 lds
  ds_read_b128 v[164:167], v15 offset:0
  v_mfma_f32_16x16x32_bf16 v[56:59], v[124:127], v[156:159], 0
  s_and_b32 s86, s4, 1
  ds_read_b128 v[168:171], v15 offset:2048
  ds_read_b64_tr_b16 v[202:203], v190 offset:1024
  v_mfma_f32_16x16x32_bf16 v[60:63], v[124:127], v[160:163], 0
  ds_read_b64_tr_b16 v[112:113], v4 offset:8192
  ds_read_b64_tr_b16 v[204:205], v190 offset:32
  s_waitcnt lgkmcnt(13)
  v_mfma_f32_16x16x32_bf16 v[64:67], v[128:131], v[156:159], 0
  s_lshl_b32 s86, s86, 4
  ds_read_b64_tr_b16 v[114:115], v4 offset:9216
  ds_read_b64_tr_b16 v[206:207], v190 offset:1056
  v_mfma_f32_16x16x32_bf16 v[68:71], v[128:131], v[160:163], 0
  buffer_load_dwordx4 v173, s[12:15], s94 offen offset:1024 lds
  ds_read_b64_tr_b16 v[116:117], v5 offset:8192
  v_mfma_f32_16x16x32_bf16 v[72:75], v[132:135], v[156:159], 0
  s_add_u32 m0, s71, 49152
  ds_read_b64_tr_b16 v[118:119], v5 offset:9216
  v_add_u32 v232, s86, v2
  v_mfma_f32_16x16x32_bf16 v[76:79], v[132:135], v[160:163], 0
  ds_read_b64_tr_b16 v[120:121], v6 offset:8192
  s_waitcnt lgkmcnt(15)
  v_mfma_f32_16x16x32_bf16 v[80:83], v[136:139], v[156:159], 0
  s_cmp_lt_u32 s2, 224
  s_cselect_b32 s89, s89, 0x7ffff000
  ds_read_b64_tr_b16 v[122:123], v6 offset:9216
  v_mfma_f32_16x16x32_bf16 v[84:87], v[136:139], v[160:163], 0
  ds_read_b64_tr_b16 v[124:125], v7 offset:8192
  s_waitcnt lgkmcnt(13)
  v_mfma_f32_16x16x32_bf16 v[88:91], v[148:151], v[156:159], 0
  buffer_load_dwordx4 v174, s[12:15], s94 offen offset:2048 lds
  ds_read_b64_tr_b16 v[126:127], v7 offset:9216
  v_mfma_f32_16x16x32_bf16 v[92:95], v[148:151], v[160:163], 0
  s_lshr_b32 s87, s4, 1
  s_mul_i32 s87, s87, 17408
  ds_read_b64_tr_b16 v[128:129], v8 offset:8192
  v_mfma_f32_16x16x32_bf16 v[104:107], v[140:143], v[152:155], 0
  s_add_u32 s87, s87, 13056
  ds_read_b64_tr_b16 v[130:131], v8 offset:9216
  v_subrev_u32 v233, 1, v3
  v_mfma_f32_16x16x32_bf16 v[108:111], v[144:147], v[152:155], 0
  s_waitcnt lgkmcnt(8)
  ds_read_b64_tr_b16 v[132:133], v9 offset:8192
  v_max_i32 v233, 0, v233
  v_mfma_f32_16x16x32_bf16 v[96:99], v[156:159], v[156:159], 0
  buffer_load_dwordx4 v175, s[12:15], s94 offen offset:3072 lds
  ds_read_b64_tr_b16 v[134:135], v9 offset:9216
  v_mfma_f32_16x16x32_bf16 v[100:103], v[160:163], v[160:163], 0
  ds_read_b64_tr_b16 v[136:137], v10 offset:8192
  ds_read_b64_tr_b16 v[138:139], v10 offset:9216
  s_waitcnt lgkmcnt(10)
  v_mfma_f32_16x16x32_bf16 v[32:35], v[112:115], v[164:167], v[32:35]
  buffer_store_dwordx4 v[200:203], v28, s[24:27], s89 offen sc1
  ds_read_b64_tr_b16 v[140:141], v11 offset:8192
  v_mfma_f32_16x16x32_bf16 v[36:39], v[112:115], v[168:171], v[36:39]
  s_add_u32 s95, s93, 3
  s_and_b32 s95, s95, 7
  ds_read_b64_tr_b16 v[142:143], v11 offset:9216
  v_mfma_f32_16x16x32_bf16 v[40:43], v[116:119], v[164:167], v[40:43]
  s_waitcnt vmcnt(15)
  s_mul_i32 s95, s95, 229376
  ds_read_b64_tr_b16 v[144:145], v12 offset:8192
  v_mfma_f32_16x16x32_bf16 v[44:47], v[116:119], v[168:171], v[44:47]
  s_add_u32 s95, s95, s70
  ds_read_b64_tr_b16 v[146:147], v12 offset:9216
  s_waitcnt lgkmcnt(10)
  v_mfma_f32_16x16x32_bf16 v[48:51], v[120:123], v[164:167], v[48:51]
  s_barrier
  s_add_u32 m0, s96, 49152
  ds_read_b128 v[148:151], v183 offset:64
  v_mfma_f32_16x16x32_bf16 v[52:55], v[120:123], v[168:171], v[52:55]
  buffer_load_dwordx4 v176, s[16:19], s95 offen offset:0 lds
  ds_read_b128 v[156:159], v14 offset:16384
  v_mfma_f32_16x16x32_bf16 v[56:59], v[124:127], v[164:167], v[56:59]
  s_add_u32 s7, s93, 1
  s_and_b32 s7, s7, 7
  ds_read_b128 v[160:163], v14 offset:18432
  v_mfma_f32_16x16x32_bf16 v[60:63], v[124:127], v[168:171], v[60:63]
  s_lshl_b32 s7, s7, 7
  ds_read_b64_tr_b16 v[112:113], v4 offset:16384
  s_waitcnt lgkmcnt(10)
  v_mfma_f32_16x16x32_bf16 v[64:67], v[128:131], v[164:167], v[64:67]
  ds_read_b64_tr_b16 v[114:115], v4 offset:17408
  v_add_u32 v183, s7, v13
  v_mfma_f32_16x16x32_bf16 v[68:71], v[128:131], v[168:171], v[68:71]
  buffer_load_dwordx4 v177, s[16:19], s95 offen offset:1024 lds
  ds_read_b64_tr_b16 v[116:117], v5 offset:16384
  v_mfma_f32_16x16x32_bf16 v[72:75], v[132:135], v[164:167], v[72:75]
  s_add_u32 s95, s95, 114688
  s_add_u32 m0, s96, 57344
  ds_read_b64_tr_b16 v[118:119], v5 offset:17408
  v_mfma_f32_16x16x32_bf16 v[76:79], v[132:135], v[168:171], v[76:79]
  ds_read_b64_tr_b16 v[120:121], v6 offset:16384
  s_waitcnt lgkmcnt(12)
  v_mfma_f32_16x16x32_bf16 v[80:83], v[136:139], v[164:167], v[80:83]
  ds_read_b64_tr_b16 v[122:123], v6 offset:17408
  v_sub_u32 v233, 3, v233
  v_mfma_f32_16x16x32_bf16 v[84:87], v[136:139], v[168:171], v[84:87]
  ds_read_b64_tr_b16 v[124:125], v7 offset:16384
  s_waitcnt lgkmcnt(9)
  v_mfma_f32_16x16x32_bf16 v[88:91], v[148:151], v[164:167], v[88:91]
  buffer_load_dwordx4 v176, s[16:19], s95 offen offset:0 lds
  ds_read_b64_tr_b16 v[126:127], v7 offset:17408
  v_mfma_f32_16x16x32_bf16 v[92:95], v[148:151], v[168:171], v[92:95]
  ds_read_b64_tr_b16 v[128:129], v8 offset:16384
  v_lshlrev_b32 v233, v233, v232
  v_mfma_f32_16x16x32_bf16 v[104:107], v[140:143], v[152:155], v[104:107]
  buffer_store_dwordx4 v[204:207], v28, s[24:27], s89 offen offset:1024 sc1
  ds_read_b64_tr_b16 v[130:131], v8 offset:17408
  v_mfma_f32_16x16x32_bf16 v[108:111], v[144:147], v[152:155], v[108:111]
  ds_read_b64_tr_b16 v[132:133], v9 offset:16384
  v_mov_b32 v234, 0
  v_mfma_f32_16x16x32_bf16 v[96:99], v[164:167], v[164:167], v[96:99]
  buffer_load_dwordx4 v177, s[16:19], s95 offen offset:1024 lds
  ds_read_b64_tr_b16 v[134:135], v9 offset:17408
  v_mfma_f32_16x16x32_bf16 v[100:103], v[168:171], v[168:171], v[100:103]
  ds_read_b64_tr_b16 v[136:137], v10 offset:16384
  ds_read_b64_tr_b16 v[138:139], v10 offset:17408
  s_waitcnt lgkmcnt(10)
  v_mfma_f32_16x16x32_bf16 v[32:35], v[112:115], v[156:159], v[32:35]
  buffer_load_dword v24, v30, s[24:27], 0 offen sc1
  ds_read_b64_tr_b16 v[140:141], v11 offset:16384
  v_mfma_f32_16x16x32_bf16 v[36:39], v[112:115], v[160:163], v[36:39]
  s_add_u32 s95, s93, 4
  s_and_b32 s95, s95, 7
  ds_read_b64_tr_b16 v[142:143], v11 offset:17408
  v_mfma_f32_16x16x32_bf16 v[40:43], v[116:119], v[156:159], v[40:43]
  s_waitcnt vmcnt(19)
  s_mul_i32 s95, s95, 229376
  ds_read_b64_tr_b16 v[144:145], v12 offset:16384
  v_mfma_f32_16x16x32_bf16 v[44:47], v[116:119], v[160:163], v[44:47]
  s_add_u32 s95, s95, s70
  ds_read_b64_tr_b16 v[146:147], v12 offset:17408
  s_waitcnt lgkmcnt(10)
  v_mfma_f32_16x16x32_bf16 v[48:51], v[120:123], v[156:159], v[48:51]
  s_barrier
  s_add_u32 m0, s96, 0
  ds_read_b128 v[148:151], v183 offset:0
  v_mfma_f32_16x16x32_bf16 v[52:55], v[120:123], v[160:163], v[52:55]
  buffer_load_dwordx4 v176, s[16:19], s95 offen offset:0 lds
  ds_read_b128 v[164:167], v15 offset:16384
  v_mfma_f32_16x16x32_bf16 v[56:59], v[124:127], v[156:159], v[56:59]
  ds_read_b128 v[168:171], v15 offset:18432
  v_mov_b32 v235, 4
  v_mfma_f32_16x16x32_bf16 v[60:63], v[124:127], v[160:163], v[60:63]
  ds_read_b64_tr_b16 v[112:113], v4 offset:24576
  s_waitcnt lgkmcnt(10)
  v_mfma_f32_16x16x32_bf16 v[64:67], v[128:131], v[156:159], v[64:67]
  ds_read_b64_tr_b16 v[114:115], v4 offset:25600
  v_cmp_eq_u32 s[90:91], 1, v3
  v_mfma_f32_16x16x32_bf16 v[68:71], v[128:131], v[160:163], v[68:71]
  buffer_load_dwordx4 v177, s[16:19], s95 offen offset:1024 lds
  ds_read_b64_tr_b16 v[116:117], v5 offset:24576
  v_mfma_f32_16x16x32_bf16 v[72:75], v[132:135], v[156:159], v[72:75]
  s_add_u32 s94, s93, 4
  s_and_b32 s94, s94, 7
  ds_read_b64_tr_b16 v[118:119], v5 offset:25600
  v_mfma_f32_16x16x32_bf16 v[76:79], v[132:135], v[160:163], v[76:79]
  s_lshl_b32 s94, s94, 7
  ds_read_b64_tr_b16 v[120:121], v6 offset:24576
  s_waitcnt lgkmcnt(12)
  v_mfma_f32_16x16x32_bf16 v[80:83], v[136:139], v[156:159], v[80:83]
  s_add_u32 s94, s94, s68
  s_add_u32 m0, s71, 0
  ds_read_b64_tr_b16 v[122:123], v6 offset:25600
  v_mfma_f32_16x16x32_bf16 v[84:87], v[136:139], v[160:163], v[84:87]
  ds_read_b64_tr_b16 v[124:125], v7 offset:24576
  s_waitcnt lgkmcnt(9)
  v_mfma_f32_16x16x32_bf16 v[88:91], v[148:151], v[156:159], v[88:91]
  buffer_load_dwordx4 v172, s[12:15], s94 offen offset:0 lds
  ds_read_b64_tr_b16 v[126:127], v7 offset:25600
  v_mfma_f32_16x16x32_bf16 v[92:95], v[148:151], v[160:163], v[92:95]
  ds_read_b64_tr_b16 v[128:129], v8 offset:24576
  v_mfma_f32_16x16x32_bf16 v[104:107], v[140:143], v[152:155], v[104:107]
  global_load_ushort v182, v29, s[54:55]
  ds_read_b64_tr_b16 v[130:131], v8 offset:25600
  v_mfma_f32_16x16x32_bf16 v[108:111], v[144:147], v[152:155], v[108:111]
  ds_read_b64_tr_b16 v[132:133], v9 offset:24576
  v_cndmask_b32 v234, v234, v235, s[90:91]
  v_mfma_f32_16x16x32_bf16 v[96:99], v[156:159], v[156:159], v[96:99]
  buffer_load_dwordx4 v173, s[12:15], s94 offen offset:1024 lds
  ds_read_b64_tr_b16 v[134:135], v9 offset:25600
  v_mfma_f32_16x16x32_bf16 v[100:103], v[160:163], v[160:163], v[100:103]
  ds_read_b64_tr_b16 v[136:137], v10 offset:24576
  ds_read_b64_tr_b16 v[138:139], v10 offset:25600
  s_waitcnt lgkmcnt(10)
  v_mfma_f32_16x16x32_bf16 v[32:35], v[112:115], v[164:167], v[32:35]
  global_load_ushort v248, v247, s[48:49]
  ds_read_b64_tr_b16 v[140:141], v11 offset:24576
  v_mfma_f32_16x16x32_bf16 v[36:39], v[112:115], v[168:171], v[36:39]
  s_add_u32 m0, s71, 0
  ds_read_b64_tr_b16 v[142:143], v11 offset:25600
  v_mov_b32 v235, 256
  v_mfma_f32_16x16x32_bf16 v[40:43], v[116:119], v[164:167], v[40:43]
  s_waitcnt vmcnt(19)
  ds_read_b64_tr_b16 v[144:145], v12 offset:24576
  v_cmp_eq_u32 s[90:91], 2, v3
  v_mfma_f32_16x16x32_bf16 v[44:47], v[116:119], v[168:171], v[44:47]
  ds_read_b64_tr_b16 v[146:147], v12 offset:25600
  s_waitcnt lgkmcnt(10)
  v_mfma_f32_16x16x32_bf16 v[48:51], v[120:123], v[164:167], v[48:51]
  s_barrier
  ds_read_b128 v[148:151], v183 offset:64
  v_mfma_f32_16x16x32_bf16 v[52:55], v[120:123], v[168:171], v[52:55]
  buffer_load_dwordx4 v174, s[12:15], s94 offen offset:2048 lds
  ds_read_b128 v[156:159], v14 offset:32768
  v_mfma_f32_16x16x32_bf16 v[56:59], v[124:127], v[164:167], v[56:59]
  s_add_u32 s7, s93, 2
  s_and_b32 s7, s7, 7
  ds_read_b128 v[160:163], v14 offset:34816
  v_mfma_f32_16x16x32_bf16 v[60:63], v[124:127], v[168:171], v[60:63]
  s_lshl_b32 s7, s7, 7
  ds_read_b64_tr_b16 v[112:113], v4 offset:32768
  s_waitcnt lgkmcnt(10)
  v_mfma_f32_16x16x32_bf16 v[64:67], v[128:131], v[164:167], v[64:67]
  ds_read_b64_tr_b16 v[114:115], v4 offset:33792
  v_add_u32 v183, s7, v13
  v_mfma_f32_16x16x32_bf16 v[68:71], v[128:131], v[168:171], v[68:71]
  buffer_load_dwordx4 v175, s[12:15], s94 offen offset:3072 lds
  ds_read_b64_tr_b16 v[116:117], v5 offset:32768
  v_mfma_f32_16x16x32_bf16 v[72:75], v[132:135], v[164:167], v[72:75]
  s_add_u32 s95, s95, 114688
  s_add_u32 m0, s96, 8192
  ds_read_b64_tr_b16 v[118:119], v5 offset:33792
  v_mfma_f32_16x16x32_bf16 v[76:79], v[132:135], v[168:171], v[76:79]
  ds_read_b64_tr_b16 v[120:121], v6 offset:32768
  s_waitcnt lgkmcnt(12)
  v_mfma_f32_16x16x32_bf16 v[80:83], v[136:139], v[164:167], v[80:83]
  ds_read_b64_tr_b16 v[122:123], v6 offset:33792
  v_cndmask_b32 v234, v234, v235, s[90:91]
  v_mfma_f32_16x16x32_bf16 v[84:87], v[136:139], v[168:171], v[84:87]
  ds_read_b64_tr_b16 v[124:125], v7 offset:32768
  s_waitcnt lgkmcnt(9)
  v_mfma_f32_16x16x32_bf16 v[88:91], v[148:151], v[164:167], v[88:91]
  buffer_load_dwordx4 v176, s[16:19], s95 offen offset:0 lds
  ds_read_b64_tr_b16 v[126:127], v7 offset:33792
  v_mfma_f32_16x16x32_bf16 v[92:95], v[148:151], v[168:171], v[92:95]
  ds_read_b64_tr_b16 v[128:129], v8 offset:32768
  v_mov_b32 v235, 384
  v_mfma_f32_16x16x32_bf16 v[104:107], v[140:143], v[152:155], v[104:107]
  global_load_ushort v249, v247, s[58:59]
  ds_read_b64_tr_b16 v[130:131], v8 offset:33792
  v_mfma_f32_16x16x32_bf16 v[108:111], v[144:147], v[152:155], v[108:111]
  ds_read_b64_tr_b16 v[132:133], v9 offset:32768
  v_cmp_eq_u32 s[90:91], 3, v3
  v_mfma_f32_16x16x32_bf16 v[96:99], v[164:167], v[164:167], v[96:99]
  buffer_load_dwordx4 v177, s[16:19], s95 offen offset:1024 lds
  ds_read_b64_tr_b16 v[134:135], v9 offset:33792
  v_mfma_f32_16x16x32_bf16 v[100:103], v[168:171], v[168:171], v[100:103]
  ds_read_b64_tr_b16 v[136:137], v10 offset:32768
  ds_read_b64_tr_b16 v[138:139], v10 offset:33792
  s_waitcnt lgkmcnt(10)
  v_mfma_f32_16x16x32_bf16 v[32:35], v[112:115], v[156:159], v[32:35]
  global_load_ushort v16, v253, s[34:35]
  ds_read_b64_tr_b16 v[140:141], v11 offset:32768
  v_mfma_f32_16x16x32_bf16 v[36:39], v[112:115], v[160:163], v[36:39]
  s_add_u32 s95, s93, 5
  s_and_b32 s95, s95, 7
  ds_read_b64_tr_b16 v[142:143], v11 offset:33792
  v_mfma_f32_16x16x32_bf16 v[40:43], v[116:119], v[156:159], v[40:43]
  s_waitcnt vmcnt(23)
  s_mul_i32 s95, s95, 229376
  ds_read_b64_tr_b16 v[144:145], v12 offset:32768
  v_mfma_f32_16x16x32_bf16 v[44:47], v[116:119], v[160:163], v[44:47]
  s_add_u32 s95, s95, s70
  ds_read_b64_tr_b16 v[146:147], v12 offset:33792
  s_waitcnt lgkmcnt(10)
  v_mfma_f32_16x16x32_bf16 v[48:51], v[120:123], v[156:159], v[48:51]
  s_barrier
  s_add_u32 m0, s96, 16384
  ds_read_b128 v[148:151], v183 offset:0
  v_mfma_f32_16x16x32_bf16 v[52:55], v[120:123], v[160:163], v[52:55]
  buffer_load_dwordx4 v176, s[16:19], s95 offen offset:0 lds
  ds_read_b128 v[164:167], v15 offset:32768
  v_mfma_f32_16x16x32_bf16 v[56:59], v[124:127], v[156:159], v[56:59]
  ds_read_b128 v[168:171], v15 offset:34816
  v_mfma_f32_16x16x32_bf16 v[60:63], v[124:127], v[160:163], v[60:63]
  ds_read_b64_tr_b16 v[112:113], v4 offset:40960
  s_waitcnt lgkmcnt(10)
  v_mfma_f32_16x16x32_bf16 v[64:67], v[128:131], v[156:159], v[64:67]
  ds_read_b64_tr_b16 v[114:115], v4 offset:41984
  v_cndmask_b32 v234, v234, v235, s[90:91]
  v_mfma_f32_16x16x32_bf16 v[68:71], v[128:131], v[160:163], v[68:71]
  buffer_load_dwordx4 v177, s[16:19], s95 offen offset:1024 lds
  ds_read_b64_tr_b16 v[116:117], v5 offset:40960
  v_mfma_f32_16x16x32_bf16 v[72:75], v[132:135], v[156:159], v[72:75]
  s_add_u32 s94, s93, 5
  s_and_b32 s94, s94, 7
  ds_read_b64_tr_b16 v[118:119], v5 offset:41984
  v_mfma_f32_16x16x32_bf16 v[76:79], v[132:135], v[160:163], v[76:79]
  s_lshl_b32 s94, s94, 7
  ds_read_b64_tr_b16 v[120:121], v6 offset:40960
  s_waitcnt lgkmcnt(12)
  v_mfma_f32_16x16x32_bf16 v[80:83], v[136:139], v[156:159], v[80:83]
  s_add_u32 s94, s94, s68
  s_add_u32 m0, s71, 16384
  ds_read_b64_tr_b16 v[122:123], v6 offset:41984
  v_mfma_f32_16x16x32_bf16 v[84:87], v[136:139], v[160:163], v[84:87]
  ds_read_b64_tr_b16 v[124:125], v7 offset:40960
  s_waitcnt lgkmcnt(9)
  v_mfma_f32_16x16x32_bf16 v[88:91], v[148:151], v[156:159], v[88:91]
  buffer_load_dwordx4 v172, s[12:15], s94 offen offset:0 lds
  ds_read_b64_tr_b16 v[126:127], v7 offset:41984
  v_mfma_f32_16x16x32_bf16 v[92:95], v[148:151], v[160:163], v[92:95]
  ds_read_b64_tr_b16 v[128:129], v8 offset:40960
  v_add_u32 v233, v233, v234
  v_mfma_f32_16x16x32_bf16 v[104:107], v[140:143], v[152:155], v[104:107]
  global_load_ushort v17, v253, s[36:37]
  ds_read_b64_tr_b16 v[130:131], v8 offset:41984
  v_mfma_f32_16x16x32_bf16 v[108:111], v[144:147], v[152:155], v[108:111]
  ds_read_b64_tr_b16 v[132:133], v9 offset:40960
  v_lshl_add_u32 v233, v233, 1, s87
  v_mfma_f32_16x16x32_bf16 v[96:99], v[156:159], v[156:159], v[96:99]
  buffer_load_dwordx4 v173, s[12:15], s94 offen offset:1024 lds
  ds_read_b64_tr_b16 v[134:135], v9 offset:41984
  v_mfma_f32_16x16x32_bf16 v[100:103], v[160:163], v[160:163], v[100:103]
  ds_read_b64_tr_b16 v[136:137], v10 offset:40960
  ds_read_b64_tr_b16 v[138:139], v10 offset:41984
  s_waitcnt lgkmcnt(10)
  s_waitcnt vmcnt(17)
  v_readfirstlane_b32 s72, v24
  s_nop 0
  s_mul_i32 s72, s72, 0x9e3779b1
  s_add_u32 s72, s72, 0x7f4a7c15
  v_mfma_f32_16x16x32_bf16 v[32:35], v[112:115], v[164:167], v[32:35]
  global_load_ushort v18, v253, s[38:39]
  ds_read_b64_tr_b16 v[140:141], v11 offset:40960
  v_mfma_f32_16x16x32_bf16 v[36:39], v[112:115], v[168:171], v[36:39]
  s_add_u32 m0, s71, 16384
  ds_read_b64_tr_b16 v[142:143], v11 offset:41984
  v_accvgpr_write_b32 a235, v233
  v_mfma_f32_16x16x32_bf16 v[40:43], v[116:119], v[164:167], v[40:43]
  s_waitcnt vmcnt(22)
  ds_read_b64_tr_b16 v[144:145], v12 offset:40960
  v_mov_b32 v234, 4
  v_mfma_f32_16x16x32_bf16 v[44:47], v[116:119], v[168:171], v[44:47]
  ds_read_b64_tr_b16 v[146:147], v12 offset:41984
  s_waitcnt lgkmcnt(10)
  v_mfma_f32_16x16x32_bf16 v[48:51], v[120:123], v[164:167], v[48:51]
  s_barrier
  ds_read_b128 v[148:151], v183 offset:64
  v_mov_b32 v235, 128
  v_mfma_f32_16x16x32_bf16 v[52:55], v[120:123], v[168:171], v[52:55]
  buffer_load_dwordx4 v174, s[12:15], s94 offen offset:2048 lds
  ds_read_b128 v[156:159], v14 offset:49152
  v_mfma_f32_16x16x32_bf16 v[56:59], v[124:127], v[164:167], v[56:59]
  s_add_u32 s7, s93, 3
  s_and_b32 s7, s7, 7
  ds_read_b128 v[160:163], v14 offset:51200
  v_mfma_f32_16x16x32_bf16 v[60:63], v[124:127], v[168:171], v[60:63]
  s_lshl_b32 s7, s7, 7
  ds_read_b64_tr_b16 v[112:113], v4 offset:49152
  s_waitcnt lgkmcnt(10)
  v_mfma_f32_16x16x32_bf16 v[64:67], v[128:131], v[164:167], v[64:67]
  ds_read_b64_tr_b16 v[114:115], v4 offset:50176
  v_add_u32 v183, s7, v13
  v_mfma_f32_16x16x32_bf16 v[68:71], v[128:131], v[168:171], v[68:71]
  buffer_load_dwordx4 v175, s[12:15], s94 offen offset:3072 lds
  ds_read_b64_tr_b16 v[116:117], v5 offset:49152
  v_mfma_f32_16x16x32_bf16 v[72:75], v[132:135], v[164:167], v[72:75]
  s_add_u32 s95, s95, 114688
  s_add_u32 m0, s96, 24576
  ds_read_b64_tr_b16 v[118:119], v5 offset:50176
  v_mfma_f32_16x16x32_bf16 v[76:79], v[132:135], v[168:171], v[76:79]
  ds_read_b64_tr_b16 v[120:121], v6 offset:49152
  s_waitcnt lgkmcnt(12)
  v_mfma_f32_16x16x32_bf16 v[80:83], v[136:139], v[164:167], v[80:83]
  ds_read_b64_tr_b16 v[122:123], v6 offset:50176
  v_cndmask_b32 v234, v234, v235, s[90:91]
  v_mfma_f32_16x16x32_bf16 v[84:87], v[136:139], v[168:171], v[84:87]
  ds_read_b64_tr_b16 v[124:125], v7 offset:49152
  s_waitcnt lgkmcnt(9)
  v_mfma_f32_16x16x32_bf16 v[88:91], v[148:151], v[164:167], v[88:91]
  buffer_load_dwordx4 v176, s[16:19], s95 offen offset:0 lds
  ds_read_b64_tr_b16 v[126:127], v7 offset:50176
  v_mfma_f32_16x16x32_bf16 v[92:95], v[148:151], v[168:171], v[92:95]
  ds_read_b64_tr_b16 v[128:129], v8 offset:49152
  v_add_u32 v234, v234, v233
  v_mfma_f32_16x16x32_bf16 v[104:107], v[140:143], v[152:155], v[104:107]
  global_load_ushort v19, v253, s[40:41]
  ds_read_b64_tr_b16 v[130:131], v8 offset:50176
  v_mfma_f32_16x16x32_bf16 v[108:111], v[144:147], v[152:155], v[108:111]
  ds_read_b64_tr_b16 v[132:133], v9 offset:49152
  v_accvgpr_write_b32 a236, v234
  v_mfma_f32_16x16x32_bf16 v[96:99], v[164:167], v[164:167], v[96:99]
  buffer_load_dwordx4 v177, s[16:19], s95 offen offset:1024 lds
  ds_read_b64_tr_b16 v[134:135], v9 offset:50176
  v_mfma_f32_16x16x32_bf16 v[100:103], v[168:171], v[168:171], v[100:103]
  ds_read_b64_tr_b16 v[136:137], v10 offset:49152
  ds_read_b64_tr_b16 v[138:139], v10 offset:50176
  s_waitcnt lgkmcnt(10)
  v_mfma_f32_16x16x32_bf16 v[32:35], v[112:115], v[156:159], v[32:35]
  s_add_u32 s95, s93, 6
  s_and_b32 s95, s95, 7
  ds_read_b64_tr_b16 v[140:141], v11 offset:49152
  v_mfma_f32_16x16x32_bf16 v[36:39], v[112:115], v[160:163], v[36:39]
  s_mul_i32 s95, s95, 229376
  s_add_u32 s95, s95, s70
  ds_read_b64_tr_b16 v[142:143], v11 offset:50176
  v_mfma_f32_16x16x32_bf16 v[40:43], v[116:119], v[156:159], v[40:43]
  s_waitcnt vmcnt(24)
  s_add_u32 m0, s96, 32768
  ds_read_b64_tr_b16 v[144:145], v12 offset:49152
  v_mfma_f32_16x16x32_bf16 v[44:47], v[116:119], v[160:163], v[44:47]
  s_lshl_b32 s10, s2, 5
  ds_read_b64_tr_b16 v[146:147], v12 offset:50176
  s_waitcnt lgkmcnt(10)
  v_mfma_f32_16x16x32_bf16 v[48:51], v[120:123], v[156:159], v[48:51]
  s_barrier
  s_add_u32 s10, s10, 77824
  ds_read_b128 v[148:151], v183 offset:0
  v_mfma_f32_16x16x32_bf16 v[52:55], v[120:123], v[160:163], v[52:55]
  buffer_load_dwordx4 v176, s[16:19], s95 offen offset:0 lds
  ds_read_b128 v[164:167], v15 offset:49152
  v_mfma_f32_16x16x32_bf16 v[56:59], v[124:127], v[156:159], v[56:59]
  s_cmp_lt_u32 s2, 224
  s_cselect_b32 s10, s10, 0x7ffff000
  ds_read_b128 v[168:171], v15 offset:51200
  v_mfma_f32_16x16x32_bf16 v[60:63], v[124:127], v[160:163], v[60:63]
  ds_read_b64_tr_b16 v[112:113], v4 offset:57344
  s_waitcnt lgkmcnt(10)
  v_mfma_f32_16x16x32_bf16 v[64:67], v[128:131], v[156:159], v[64:67]
  ds_read_b64_tr_b16 v[114:115], v4 offset:58368
  v_mov_b32 v240, s72
  v_mfma_f32_16x16x32_bf16 v[68:71], v[128:131], v[160:163], v[68:71]
  buffer_load_dwordx4 v177, s[16:19], s95 offen offset:1024 lds
  ds_read_b64_tr_b16 v[116:117], v5 offset:57344
  v_mfma_f32_16x16x32_bf16 v[72:75], v[132:135], v[156:159], v[72:75]
  s_add_u32 s94, s93, 6
  s_and_b32 s94, s94, 7
  ds_read_b64_tr_b16 v[118:119], v5 offset:58368
  v_mfma_f32_16x16x32_bf16 v[76:79], v[132:135], v[160:163], v[76:79]
  s_lshl_b32 s94, s94, 7
  ds_read_b64_tr_b16 v[120:121], v6 offset:57344
  s_waitcnt lgkmcnt(12)
  v_mfma_f32_16x16x32_bf16 v[80:83], v[136:139], v[156:159], v[80:83]
  s_add_u32 s94, s94, s68
  s_add_u32 m0, s71, 32768
  ds_read_b64_tr_b16 v[122:123], v6 offset:58368
  v_mfma_f32_16x16x32_bf16 v[84:87], v[136:139], v[160:163], v[84:87]
  ds_read_b64_tr_b16 v[124:125], v7 offset:57344
  s_waitcnt lgkmcnt(9)
  v_mfma_f32_16x16x32_bf16 v[88:91], v[148:151], v[156:159], v[88:91]
  buffer_load_dwordx4 v172, s[12:15], s94 offen offset:0 lds
  ds_read_b64_tr_b16 v[126:127], v7 offset:58368
  v_mfma_f32_16x16x32_bf16 v[92:95], v[148:151], v[160:163], v[92:95]
  ds_read_b64_tr_b16 v[128:129], v8 offset:57344
  v_mov_b32 v233, 1600
  v_mfma_f32_16x16x32_bf16 v[104:107], v[140:143], v[152:155], v[104:107]
  s_mov_b64 exec, 1
  buffer_store_dword v240, v30, s[24:27], s10 offen sc1
  s_mov_b64 exec, -1
  ds_read_b64_tr_b16 v[130:131], v8 offset:58368
  v_mfma_f32_16x16x32_bf16 v[108:111], v[144:147], v[152:155], v[108:111]
  ds_read_b64_tr_b16 v[132:133], v9 offset:57344
  v_lshlrev_b32 v234, 1, v232
  v_mfma_f32_16x16x32_bf16 v[96:99], v[156:159], v[156:159], v[96:99]
  buffer_load_dwordx4 v173, s[12:15], s94 offen offset:1024 lds
  ds_read_b64_tr_b16 v[134:135], v9 offset:58368
  v_mfma_f32_16x16x32_bf16 v[100:103], v[160:163], v[160:163], v[100:103]
  ds_read_b64_tr_b16 v[136:137], v10 offset:57344
  ds_read_b64_tr_b16 v[138:139], v10 offset:58368
  s_waitcnt lgkmcnt(10)
  v_mfma_f32_16x16x32_bf16 v[32:35], v[112:115], v[164:167], v[32:35]
  global_load_ushort v20, v253, s[42:43]
  ds_read_b64_tr_b16 v[140:141], v11 offset:57344
  v_mfma_f32_16x16x32_bf16 v[36:39], v[112:115], v[168:171], v[36:39]
  s_add_u32 m0, s71, 32768
  ds_read_b64_tr_b16 v[142:143], v11 offset:58368
  v_add_u32 v234, 1024, v234
  v_mfma_f32_16x16x32_bf16 v[40:43], v[116:119], v[164:167], v[40:43]
  s_waitcnt vmcnt(21)
  ds_read_b64_tr_b16 v[144:145], v12 offset:57344
  v_cmp_eq_u32 s[90:91], 0, v3
  v_mfma_f32_16x16x32_bf16 v[44:47], v[116:119], v[168:171], v[44:47]
  ds_read_b64_tr_b16 v[146:147], v12 offset:58368
  s_waitcnt lgkmcnt(10)
  v_mfma_f32_16x16x32_bf16 v[48:51], v[120:123], v[164:167], v[48:51]
  s_barrier
  ds_read_b128 v[148:151], v183 offset:64
  v_mfma_f32_16x16x32_bf16 v[52:55], v[120:123], v[168:171], v[52:55]
  buffer_load_dwordx4 v174, s[12:15], s94 offen offset:2048 lds
  ds_read_b128 v[156:159], v14 offset:0
  v_mfma_f32_16x16x32_bf16 v[56:59], v[124:127], v[164:167], v[56:59]
  s_add_u32 s7, s93, 4
  s_and_b32 s7, s7, 7
  ds_read_b128 v[160:163], v14 offset:2048
  v_mfma_f32_16x16x32_bf16 v[60:63], v[124:127], v[168:171], v[60:63]
  s_lshl_b32 s7, s7, 7
  ds_read_b64_tr_b16 v[112:113], v4 offset:0
  s_waitcnt lgkmcnt(10)
  v_mfma_f32_16x16x32_bf16 v[64:67], v[128:131], v[164:167], v[64:67]
  ds_read_b64_tr_b16 v[114:115], v4 offset:1024
  v_add_u32 v183, s7, v13
  v_mfma_f32_16x16x32_bf16 v[68:71], v[128:131], v[168:171], v[68:71]
  buffer_load_dwordx4 v175, s[12:15], s94 offen offset:3072 lds
  ds_read_b64_tr_b16 v[116:117], v5 offset:0
  v_mfma_f32_16x16x32_bf16 v[72:75], v[132:135], v[164:167], v[72:75]
  s_add_u32 s95, s95, 114688
  s_add_u32 m0, s96, 40960
  ds_read_b64_tr_b16 v[118:119], v5 offset:1024
  v_mfma_f32_16x16x32_bf16 v[76:79], v[132:135], v[168:171], v[76:79]
  ds_read_b64_tr_b16 v[120:121], v6 offset:0
  s_waitcnt lgkmcnt(12)
  v_mfma_f32_16x16x32_bf16 v[80:83], v[136:139], v[164:167], v[80:83]
  ds_read_b64_tr_b16 v[122:123], v6 offset:1024
  v_cndmask_b32 v233, v233, v234, s[90:91]
  v_mfma_f32_16x16x32_bf16 v[84:87], v[136:139], v[168:171], v[84:87]
  ds_read_b64_tr_b16 v[124:125], v7 offset:0
  s_waitcnt lgkmcnt(9)
  v_mfma_f32_16x16x32_bf16 v[88:91], v[148:151], v[164:167], v[88:91]
  buffer_load_dwordx4 v176, s[16:19], s95 offen offset:0 lds
  ds_read_b64_tr_b16 v[126:127], v7 offset:1024
  v_mfma_f32_16x16x32_bf16 v[92:95], v[148:151], v[168:171], v[92:95]
  ds_read_b64_tr_b16 v[128:129], v8 offset:0
  v_lshl_add_u32 v234, v3, 8, v232
  v_mfma_f32_16x16x32_bf16 v[104:107], v[140:143], v[152:155], v[104:107]
  global_load_ushort v21, v253, s[44:45]
  ds_read_b64_tr_b16 v[130:131], v8 offset:1024
  v_mfma_f32_16x16x32_bf16 v[108:111], v[144:147], v[152:155], v[108:111]
  ds_read_b64_tr_b16 v[132:133], v9 offset:0
  v_mov_b32 v235, 1280
  v_mfma_f32_16x16x32_bf16 v[96:99], v[164:167], v[164:167], v[96:99]
  buffer_load_dwordx4 v177, s[16:19], s95 offen offset:1024 lds
  ds_read_b64_tr_b16 v[134:135], v9 offset:1024
  v_mfma_f32_16x16x32_bf16 v[100:103], v[168:171], v[168:171], v[100:103]
  ds_read_b64_tr_b16 v[136:137], v10 offset:0
  ds_read_b64_tr_b16 v[138:139], v10 offset:1024
  s_waitcnt lgkmcnt(10)
  v_mfma_f32_16x16x32_bf16 v[32:35], v[112:115], v[156:159], v[32:35]
  global_load_ushort v22, v31, s[46:47]
  ds_read_b64_tr_b16 v[140:141], v11 offset:0
  v_mfma_f32_16x16x32_bf16 v[36:39], v[112:115], v[160:163], v[36:39]
  s_add_u32 s95, s93, 7
  s_and_b32 s95, s95, 7
  ds_read_b64_tr_b16 v[142:143], v11 offset:1024
  v_mfma_f32_16x16x32_bf16 v[40:43], v[116:119], v[156:159], v[40:43]
  s_waitcnt vmcnt(24)
  s_mul_i32 s95, s95, 229376
  ds_read_b64_tr_b16 v[144:145], v12 offset:0
  v_mfma_f32_16x16x32_bf16 v[44:47], v[116:119], v[160:163], v[44:47]
  s_add_u32 s95, s95, s70
  ds_read_b64_tr_b16 v[146:147], v12 offset:1024
  s_waitcnt lgkmcnt(10)
  v_mfma_f32_16x16x32_bf16 v[48:51], v[120:123], v[156:159], v[48:51]
  s_barrier
  s_add_u32 m0, s96, 49152
  ds_read_b128 v[148:151], v183 offset:0
  v_mfma_f32_16x16x32_bf16 v[52:55], v[120:123], v[160:163], v[52:55]
  buffer_load_dwordx4 v176, s[16:19], s95 offen offset:0 lds
  ds_read_b128 v[164:167], v15 offset:0
  v_mfma_f32_16x16x32_bf16 v[56:59], v[124:127], v[156:159], v[56:59]
  ds_read_b128 v[168:171], v15 offset:2048
  v_mul_u32_u24 v198, 24, v0
  v_mfma_f32_16x16x32_bf16 v[60:63], v[124:127], v[160:163], v[60:63]
  ds_read_b64_tr_b16 v[112:113], v4 offset:8192
  s_waitcnt lgkmcnt(10)
  v_mfma_f32_16x16x32_bf16 v[64:67], v[128:131], v[156:159], v[64:67]
  s_add_u32 s84, s84, L_gtab-L_pc
  s_addc_u32 s85, s85, 0
  ds_read_b64_tr_b16 v[114:115], v4 offset:9216
  v_mfma_f32_16x16x32_bf16 v[68:71], v[128:131], v[160:163], v[68:71]
  buffer_load_dwordx4 v177, s[16:19], s95 offen offset:1024 lds
  ds_read_b64_tr_b16 v[116:117], v5 offset:8192
  v_mfma_f32_16x16x32_bf16 v[72:75], v[132:135], v[156:159], v[72:75]
  s_add_u32 s94, s93, 7
  s_and_b32 s94, s94, 7
  ds_read_b64_tr_b16 v[118:119], v5 offset:9216
  v_mfma_f32_16x16x32_bf16 v[76:79], v[132:135], v[160:163], v[76:79]
  s_lshl_b32 s94, s94, 7
  ds_read_b64_tr_b16 v[120:121], v6 offset:8192
  s_waitcnt lgkmcnt(12)
  v_mfma_f32_16x16x32_bf16 v[80:83], v[136:139], v[156:159], v[80:83]
  s_add_u32 s94, s94, s68
  s_add_u32 m0, s71, 49152
  ds_read_b64_tr_b16 v[122:123], v6 offset:9216
  v_mfma_f32_16x16x32_bf16 v[84:87], v[136:139], v[160:163], v[84:87]
  ds_read_b64_tr_b16 v[124:125], v7 offset:8192
  s_waitcnt lgkmcnt(9)
  v_mfma_f32_16x16x32_bf16 v[88:91], v[148:151], v[156:159], v[88:91]
  buffer_load_dwordx4 v172, s[12:15], s94 offen offset:0 lds
  ds_read_b64_tr_b16 v[126:127], v7 offset:9216
  v_mfma_f32_16x16x32_bf16 v[92:95], v[148:151], v[160:163], v[92:95]
  ds_read_b64_tr_b16 v[128:129], v8 offset:8192
  v_mov_b32 v236, 0x100
  v_mfma_f32_16x16x32_bf16 v[104:107], v[140:143], v[152:155], v[104:107]
  global_load_dwordx4 a[224:227], v198, s[84:85]
  ds_read_b64_tr_b16 v[130:131], v8 offset:9216
  v_mfma_f32_16x16x32_bf16 v[108:111], v[144:147], v[152:155], v[108:111]
  ds_read_b64_tr_b16 v[132:133], v9 offset:8192
  v_cmp_eq_u32 s[90:91], v236, v234
  v_mfma_f32_16x16x32_bf16 v[96:99], v[156:159], v[156:159], v[96:99]
  buffer_load_dwordx4 v173, s[12:15], s94 offen offset:1024 lds
  ds_read_b64_tr_b16 v[134:135], v9 offset:9216
  v_mfma_f32_16x16x32_bf16 v[100:103], v[160:163], v[160:163], v[100:103]
  ds_read_b64_tr_b16 v[136:137], v10 offset:8192
  ds_read_b64_tr_b16 v[138:139], v10 offset:9216
  s_waitcnt lgkmcnt(10)
  v_mfma_f32_16x16x32_bf16 v[32:35], v[112:115], v[164:167], v[32:35]
  global_load_dwordx2 a[228:229], v198, s[84:85] offset:16
  ds_read_b64_tr_b16 v[140:141], v11 offset:8192
  v_mfma_f32_16x16x32_bf16 v[36:39], v[112:115], v[168:171], v[36:39]
  s_add_u32 m0, s71, 49152
  ds_read_b64_tr_b16 v[142:143], v11 offset:9216
  v_lshrrev_b32 v197, 3, v1
  v_mfma_f32_16x16x32_bf16 v[40:43], v[116:119], v[164:167], v[40:43]
  s_waitcnt vmcnt(21)
  ds_read_b64_tr_b16 v[144:145], v12 offset:8192
  v_and_b32 v23, 7, v1
  v_mfma_f32_16x16x32_bf16 v[44:47], v[116:119], v[168:171], v[44:47]
  ds_read_b64_tr_b16 v[146:147], v12 offset:9216
  s_waitcnt lgkmcnt(10)
  v_mfma_f32_16x16x32_bf16 v[48:51], v[120:123], v[164:167], v[48:51]
  s_barrier
  ds_read_b128 v[148:151], v183 offset:64
  v_xor_b32 v23, v23, v197
  v_mfma_f32_16x16x32_bf16 v[52:55], v[120:123], v[168:171], v[52:55]
  buffer_load_dwordx4 v174, s[12:15], s94 offen offset:2048 lds
  ds_read_b128 v[156:159], v14 offset:16384
  v_mfma_f32_16x16x32_bf16 v[56:59], v[124:127], v[164:167], v[56:59]
  s_add_u32 s7, s93, 5
  s_and_b32 s7, s7, 7
  ds_read_b128 v[160:163], v14 offset:18432
  v_mfma_f32_16x16x32_bf16 v[60:63], v[124:127], v[168:171], v[60:63]
  s_lshl_b32 s7, s7, 7
  ds_read_b64_tr_b16 v[112:113], v4 offset:16384
  s_waitcnt lgkmcnt(10)
  v_mfma_f32_16x16x32_bf16 v[64:67], v[128:131], v[164:167], v[64:67]
  ds_read_b64_tr_b16 v[114:115], v4 offset:17408
  v_add_u32 v183, s7, v13
  v_mfma_f32_16x16x32_bf16 v[68:71], v[128:131], v[168:171], v[68:71]
  buffer_load_dwordx4 v175, s[12:15], s94 offen offset:3072 lds
  ds_read_b64_tr_b16 v[116:117], v5 offset:16384
  v_mfma_f32_16x16x32_bf16 v[72:75], v[132:135], v[164:167], v[72:75]
  s_add_u32 s95, s95, 114688
  s_add_u32 m0, s96, 57344
  ds_read_b64_tr_b16 v[118:119], v5 offset:17408
  v_mfma_f32_16x16x32_bf16 v[76:79], v[132:135], v[168:171], v[76:79]
  ds_read_b64_tr_b16 v[120:121], v6 offset:16384
  s_waitcnt lgkmcnt(12)
  v_mfma_f32_16x16x32_bf16 v[80:83], v[136:139], v[164:167], v[80:83]
  ds_read_b64_tr_b16 v[122:123], v6 offset:17408
  v_lshlrev_b32 v23, 4, v23
  v_mfma_f32_16x16x32_bf16 v[84:87], v[136:139], v[168:171], v[84:87]
  ds_read_b64_tr_b16 v[124:125], v7 offset:16384
  s_waitcnt lgkmcnt(9)
  v_mfma_f32_16x16x32_bf16 v[88:91], v[148:151], v[164:167], v[88:91]
  buffer_load_dwordx4 v176, s[16:19], s95 offen offset:0 lds
  ds_read_b64_tr_b16 v[126:127], v7 offset:17408
  v_mfma_f32_16x16x32_bf16 v[92:95], v[148:151], v[168:171], v[92:95]
  ds_read_b64_tr_b16 v[128:129], v8 offset:16384
  v_lshl_add_u32 v23, v197, 10, v23
  v_mfma_f32_16x16x32_bf16 v[104:107], v[140:143], v[152:155], v[104:107]
  ds_read_b64_tr_b16 v[130:131], v8 offset:17408
  v_mfma_f32_16x16x32_bf16 v[108:111], v[144:147], v[152:155], v[108:111]
  ds_read_b64_tr_b16 v[132:133], v9 offset:16384
  v_cndmask_b32 v233, v233, v235, s[90:91]
  v_mfma_f32_16x16x32_bf16 v[96:99], v[164:167], v[164:167], v[96:99]
  buffer_load_dwordx4 v177, s[16:19], s95 offen offset:1024 lds
  ds_read_b64_tr_b16 v[134:135], v9 offset:17408
  v_mfma_f32_16x16x32_bf16 v[100:103], v[168:171], v[168:171], v[100:103]
  ds_read_b64_tr_b16 v[136:137], v10 offset:16384
  ds_read_b64_tr_b16 v[138:139], v10 offset:17408
  s_waitcnt lgkmcnt(10)
  v_mfma_f32_16x16x32_bf16 v[32:35], v[112:115], v[156:159], v[32:35]
  s_lshl_b32 s3, s4, 11
  s_add_u32 m0, s3, 134400
  s_lshl_b32 s50, s6, 6
  s_add_u32 s50, s50, s68
  s_add_u32 s51, s50, 15360
  ds_read_b64_tr_b16 v[140:141], v11 offset:16384
  v_add_u32 v233, s87, v233
  v_mfma_f32_16x16x32_bf16 v[36:39], v[112:115], v[160:163], v[36:39]
  ds_read_b64_tr_b16 v[142:143], v11 offset:17408
  v_accvgpr_write_b32 a237, v233
  v_mfma_f32_16x16x32_bf16 v[40:43], v[116:119], v[156:159], v[40:43]
  s_waitcnt vmcnt(22)
  ds_read_b64_tr_b16 v[144:145], v12 offset:16384
  v_sub_u32 v232, 3, v2
  v_mfma_f32_16x16x32_bf16 v[44:47], v[116:119], v[160:163], v[44:47]
  ds_read_b64_tr_b16 v[146:147], v12 offset:17408
  s_waitcnt lgkmcnt(10)
  v_mfma_f32_16x16x32_bf16 v[48:51], v[120:123], v[156:159], v[48:51]
  s_barrier
  ds_read_b128 v[148:151], v183 offset:0
  v_and_b32 v232, 3, v232
  v_mfma_f32_16x16x32_bf16 v[52:55], v[120:123], v[160:163], v[52:55]
  buffer_load_dwordx4 v178, s[12:15], s50 offen lds
  ds_read_b128 v[164:167], v15 offset:16384
  v_mfma_f32_16x16x32_bf16 v[56:59], v[124:127], v[156:159], v[56:59]
  ds_read_b128 v[168:171], v15 offset:18432
  v_sub_u32 v233, 2031, v2
  v_mfma_f32_16x16x32_bf16 v[60:63], v[124:127], v[160:163], v[60:63]
  ds_read_b64_tr_b16 v[112:113], v4 offset:24576
  s_waitcnt lgkmcnt(10)
  v_mfma_f32_16x16x32_bf16 v[64:67], v[128:131], v[156:159], v[64:67]
  ds_read_b64_tr_b16 v[114:115], v4 offset:25600
  v_lshl_add_u32 v233, v3, 3, v233
  v_mfma_f32_16x16x32_bf16 v[68:71], v[128:131], v[160:163], v[68:71]
  buffer_load_dwordx4 v178, s[12:15], s51 offen offset:1024 lds
  ds_read_b64_tr_b16 v[116:117], v5 offset:24576
  v_mfma_f32_16x16x32_bf16 v[72:75], v[132:135], v[156:159], v[72:75]
  s_lshl_b32 s3, s4, 11
  s_add_u32 m0, s3, 152576
  s_lshl_b32 s50, s8, 2
  s_add_u32 s50, s50, s4
  s_lshl_b32 s50, s50, 14
  s_lshl_b32 s51, s9, 7
  s_add_u32 s50, s50, s51
  s_add_u32 s51, s50, 7168
  ds_read_b64_tr_b16 v[118:119], v5 offset:25600
  v_sub_u32 v233, v233, v232
  v_mfma_f32_16x16x32_bf16 v[76:79], v[132:135], v[160:163], v[76:79]
  ds_read_b64_tr_b16 v[120:121], v6 offset:24576
  s_waitcnt lgkmcnt(12)
  v_mfma_f32_16x16x32_bf16 v[80:83], v[136:139], v[156:159], v[80:83]
  ds_read_b64_tr_b16 v[122:123], v6 offset:25600
  v_lshlrev_b32 v233, 1, v233
  v_mfma_f32_16x16x32_bf16 v[84:87], v[136:139], v[160:163], v[84:87]
  ds_read_b64_tr_b16 v[124:125], v7 offset:24576
  s_waitcnt lgkmcnt(9)
  v_mfma_f32_16x16x32_bf16 v[88:91], v[148:151], v[156:159], v[88:91]
  buffer_load_dwordx4 v23, s[12:15], s50 offen lds
  ds_read_b64_tr_b16 v[126:127], v7 offset:25600
  v_mfma_f32_16x16x32_bf16 v[92:95], v[148:151], v[160:163], v[92:95]
  ds_read_b64_tr_b16 v[128:129], v8 offset:24576
  v_mul_u32_u24 v232, 4160, v232
  v_mfma_f32_16x16x32_bf16 v[104:107], v[140:143], v[152:155], v[104:107]
  ds_read_b64_tr_b16 v[130:131], v8 offset:25600
  v_add_u32 v233, v233, v232
  v_mfma_f32_16x16x32_bf16 v[108:111], v[144:147], v[152:155], v[108:111]
  s_lshr_b32 s86, s4, 1
  s_mul_i32 s86, s86, 16640
  ds_read_b64_tr_b16 v[132:133], v9 offset:24576
  v_mfma_f32_16x16x32_bf16 v[96:99], v[156:159], v[156:159], v[96:99]
  buffer_load_dwordx4 v23, s[12:15], s51 offen offset:1024 lds
  ds_read_b64_tr_b16 v[134:135], v9 offset:25600
  v_mfma_f32_16x16x32_bf16 v[100:103], v[160:163], v[160:163], v[100:103]
  ds_read_b64_tr_b16 v[136:137], v10 offset:24576
  ds_read_b64_tr_b16 v[138:139], v10 offset:25600
  s_waitcnt lgkmcnt(10)
  v_mfma_f32_16x16x32_bf16 v[32:35], v[112:115], v[164:167], v[32:35]
  buffer_load_dword v26, v27, s[24:27], 0 offen sc1
  ds_read_b64_tr_b16 v[140:141], v11 offset:24576
  v_mfma_f32_16x16x32_bf16 v[36:39], v[112:115], v[168:171], v[36:39]
  s_and_b32 s87, s4, 1
  s_lshl_b32 s87, s87, 8
  ds_read_b64_tr_b16 v[142:143], v11 offset:25600
  v_mfma_f32_16x16x32_bf16 v[40:43], v[116:119], v[164:167], v[40:43]
  s_waitcnt vmcnt(19)
  s_sub_u32 s86, s86, s87
  ds_read_b64_tr_b16 v[144:145], v12 offset:24576
  v_mfma_f32_16x16x32_bf16 v[44:47], v[116:119], v[168:171], v[44:47]
  ds_read_b64_tr_b16 v[146:147], v12 offset:25600
  s_waitcnt lgkmcnt(10)
  v_mfma_f32_16x16x32_bf16 v[48:51], v[120:123], v[164:167], v[48:51]
  s_barrier
  s_add_u32 s86, s86, 69952
  ds_read_b128 v[148:151], v183 offset:64
  v_mfma_f32_16x16x32_bf16 v[52:55], v[120:123], v[168:171], v[52:55]
  s_add_u32 s7, s93, 6
  s_and_b32 s7, s7, 7
  ds_read_b128 v[156:159], v14 offset:32768
  v_mfma_f32_16x16x32_bf16 v[56:59], v[124:127], v[164:167], v[56:59]
  s_lshl_b32 s7, s7, 7
  ds_read_b128 v[160:163], v14 offset:34816
  v_add_u32 v183, s7, v13
  v_mfma_f32_16x16x32_bf16 v[60:63], v[124:127], v[168:171], v[60:63]
  ds_read_b64_tr_b16 v[112:113], v4 offset:32768
  s_waitcnt lgkmcnt(10)
  v_mfma_f32_16x16x32_bf16 v[64:67], v[128:131], v[164:167], v[64:67]
  ds_read_b64_tr_b16 v[114:115], v4 offset:33792
  v_add_u32 v233, s86, v233
  v_mfma_f32_16x16x32_bf16 v[68:71], v[128:131], v[168:171], v[68:71]
  ds_read_b64_tr_b16 v[116:117], v5 offset:32768
  v_accvgpr_write_b32 a238, v233
  v_mfma_f32_16x16x32_bf16 v[72:75], v[132:135], v[164:167], v[72:75]
  ds_read_b64_tr_b16 v[118:119], v5 offset:33792
  v_lshlrev_b32 v233, 5, v2
  v_mfma_f32_16x16x32_bf16 v[76:79], v[132:135], v[168:171], v[76:79]
  ds_read_b64_tr_b16 v[120:121], v6 offset:32768
  s_waitcnt lgkmcnt(12)
  v_mfma_f32_16x16x32_bf16 v[80:83], v[136:139], v[164:167], v[80:83]
  ds_read_b64_tr_b16 v[122:123], v6 offset:33792
  v_lshl_add_u32 v233, v3, 4, v233
  v_mfma_f32_16x16x32_bf16 v[84:87], v[136:139], v[168:171], v[84:87]
  ds_read_b64_tr_b16 v[124:125], v7 offset:32768
  s_waitcnt lgkmcnt(9)
  v_mfma_f32_16x16x32_bf16 v[88:91], v[148:151], v[164:167], v[88:91]
  s_lshr_b32 s86, s4, 1
  s_mul_i32 s86, s86, 4608
  ds_read_b64_tr_b16 v[126:127], v7 offset:33792
  v_mfma_f32_16x16x32_bf16 v[92:95], v[148:151], v[168:171], v[92:95]
  s_sub_u32 s86, s86, s87
  s_add_u32 s86, s86, 107296
  ds_read_b64_tr_b16 v[128:129], v8 offset:32768
  v_mfma_f32_16x16x32_bf16 v[104:107], v[140:143], v[152:155], v[104:107]
  ds_read_b64_tr_b16 v[130:131], v8 offset:33792
  v_add_u32 v233, s86, v233
  v_mfma_f32_16x16x32_bf16 v[108:111], v[144:147], v[152:155], v[108:111]
  ds_read_b64_tr_b16 v[132:133], v9 offset:32768
  v_accvgpr_write_b32 a239, v233
  v_mfma_f32_16x16x32_bf16 v[96:99], v[164:167], v[164:167], v[96:99]
  s_lshr_b32 s86, s2, 4
  s_lshl_b32 s86, s86, 5
  ds_read_b64_tr_b16 v[134:135], v9 offset:33792
  v_mfma_f32_16x16x32_bf16 v[100:103], v[168:171], v[168:171], v[100:103]
  ds_read_b64_tr_b16 v[136:137], v10 offset:32768
  ds_read_b64_tr_b16 v[138:139], v10 offset:33792
  s_waitcnt lgkmcnt(10)
  v_mfma_f32_16x16x32_bf16 v[32:35], v[112:115], v[156:159], v[32:35]
  s_waitcnt vmcnt(40)
  ds_read_b64_tr_b16 v[140:141], v11 offset:32768
  v_lshlrev_b32 v182, 16, v182
  v_mfma_f32_16x16x32_bf16 v[36:39], v[112:115], v[160:163], v[36:39]
  ds_read_b64_tr_b16 v[142:143], v11 offset:33792
  v_and_b32 v196, 127, v0
  v_mfma_f32_16x16x32_bf16 v[40:43], v[116:119], v[156:159], v[40:43]
  s_waitcnt vmcnt(16)
  ds_read_b64_tr_b16 v[144:145], v12 offset:32768
  v_lshlrev_b32 v196, 2, v196
  v_mfma_f32_16x16x32_bf16 v[44:47], v[116:119], v[160:163], v[44:47]
  ds_read_b64_tr_b16 v[146:147], v12 offset:33792
  s_waitcnt lgkmcnt(10)
  v_mfma_f32_16x16x32_bf16 v[48:51], v[120:123], v[156:159], v[48:51]
  s_barrier
  ds_read_b128 v[148:151], v183 offset:0
  v_add_u32 v196, 143104, v196
  v_mfma_f32_16x16x32_bf16 v[52:55], v[120:123], v[160:163], v[52:55]
  ds_read_b128 v[164:167], v15 offset:32768
  ds_write_b32 v196, v182
  v_lshlrev_b32 v248, 16, v248
  v_mfma_f32_16x16x32_bf16 v[56:59], v[124:127], v[156:159], v[56:59]
  ds_read_b128 v[168:171], v15 offset:34816
  v_lshlrev_b32 v249, 16, v249
  v_mfma_f32_16x16x32_bf16 v[60:63], v[124:127], v[160:163], v[60:63]
  ds_read_b64_tr_b16 v[112:113], v4 offset:40960
  s_waitcnt lgkmcnt(11)
  v_mfma_f32_16x16x32_bf16 v[64:67], v[128:131], v[156:159], v[64:67]
  ds_read_b64_tr_b16 v[114:115], v4 offset:41984
  v_lshlrev_b32 v196, 2, v1
  v_mfma_f32_16x16x32_bf16 v[68:71], v[128:131], v[160:163], v[68:71]
  ds_read_b64_tr_b16 v[116:117], v5 offset:40960
  v_add_u32 v196, 152064, v196
  v_mfma_f32_16x16x32_bf16 v[72:75], v[132:135], v[156:159], v[72:75]
  ds_read_b64_tr_b16 v[118:119], v5 offset:41984
  ds_write_b32 v196, v248
  v_lshlrev_b32 v233, 9, v2
  v_mfma_f32_16x16x32_bf16 v[76:79], v[132:135], v[160:163], v[76:79]
  ds_read_b64_tr_b16 v[120:121], v6 offset:40960
  ds_write_b32 v196, v249 offset:256
  s_waitcnt lgkmcnt(15)
  v_mfma_f32_16x16x32_bf16 v[80:83], v[136:139], v[156:159], v[80:83]
  ds_read_b64_tr_b16 v[122:123], v6 offset:41984
  v_add_u32 v233, s86, v233
  v_mfma_f32_16x16x32_bf16 v[84:87], v[136:139], v[160:163], v[84:87]
  ds_read_b64_tr_b16 v[124:125], v7 offset:40960
  s_waitcnt lgkmcnt(12)
  v_mfma_f32_16x16x32_bf16 v[88:91], v[148:151], v[156:159], v[88:91]
  s_lshr_b32 s86, s8, 1
  s_lshl_b32 s86, s86, 9
  ds_read_b64_tr_b16 v[126:127], v7 offset:41984
  v_mfma_f32_16x16x32_bf16 v[92:95], v[148:151], v[160:163], v[92:95]
  ds_read_b64_tr_b16 v[128:129], v8 offset:40960
  v_lshlrev_b32 v234, 5, v2
  v_mfma_f32_16x16x32_bf16 v[104:107], v[140:143], v[152:155], v[104:107]
  ds_read_b64_tr_b16 v[130:131], v8 offset:41984
  v_add_u32 v234, s86, v234
  v_mfma_f32_16x16x32_bf16 v[108:111], v[144:147], v[152:155], v[108:111]
  ds_read_b64_tr_b16 v[132:133], v9 offset:40960
  v_and_b32 v235, 1, v3
  v_mfma_f32_16x16x32_bf16 v[96:99], v[156:159], v[156:159], v[96:99]
  ds_read_b64_tr_b16 v[134:135], v9 offset:41984
  v_cmp_eq_u32 s[90:91], 1, v235
  v_mfma_f32_16x16x32_bf16 v[100:103], v[160:163], v[160:163], v[100:103]
  ds_read_b64_tr_b16 v[136:137], v10 offset:40960
  ds_read_b64_tr_b16 v[138:139], v10 offset:41984
  s_waitcnt lgkmcnt(12)
  s_waitcnt vmcnt(0)
  v_cmp_ne_u32 vcc, s72, v26
  s_nop 0
  s_cmp_eq_u64 vcc, 0
  s_cbranch_scc1 L_ok_W
  s_mov_b32 s92, 400000
L_poll_W:
  s_sleep 2
  buffer_load_dword v26, v27, s[24:27], 0 offen sc1
  s_waitcnt vmcnt(0)
  v_cmp_ne_u32 vcc, s72, v26
  s_sub_u32 s92, s92, 1
  s_cmp_eq_u32 s92, 0
  s_cbranch_scc1 L_ok_W
  s_cmp_lg_u64 vcc, 0
  s_cbranch_scc1 L_poll_W
L_ok_W:
  v_mfma_f32_16x16x32_bf16 v[32:35], v[112:115], v[164:167], v[32:35]
  s_add_u32 s50, s97, 0
  ds_read_b64_tr_b16 v[140:141], v11 offset:40960
  v_lshrrev_b32 v200, 2, v2
  v_mfma_f32_16x16x32_bf16 v[36:39], v[112:115], v[168:171], v[36:39]
  buffer_load_dwordx4 a[0:3], v28, s[24:27], s50 offen offset:0 sc1
  ds_read_b64_tr_b16 v[142:143], v11 offset:41984
  v_mfma_f32_16x16x32_bf16 v[40:43], v[116:119], v[164:167], v[40:43]
  s_waitcnt vmcnt(8)
  ds_read_b64_tr_b16 v[144:145], v12 offset:40960
  v_lshl_add_u32 v200, v3, 3, v200
  v_mfma_f32_16x16x32_bf16 v[44:47], v[116:119], v[168:171], v[44:47]
  ds_read_b64_tr_b16 v[146:147], v12 offset:41984
  s_waitcnt lgkmcnt(10)
  v_mfma_f32_16x16x32_bf16 v[48:51], v[120:123], v[164:167], v[48:51]
  s_barrier
  ds_read_b128 v[148:151], v183 offset:64
  v_lshlrev_b32 v200, 6, v200
  v_mfma_f32_16x16x32_bf16 v[52:55], v[120:123], v[168:171], v[52:55]
  buffer_load_dwordx4 a[4:7], v28, s[24:27], s50 offen offset:1024 sc1
  ds_read_b128 v[156:159], v14 offset:49152
  v_mfma_f32_16x16x32_bf16 v[56:59], v[124:127], v[164:167], v[56:59]
  s_add_u32 s7, s93, 7
  s_and_b32 s7, s7, 7
  ds_read_b128 v[160:163], v14 offset:51200
  v_mfma_f32_16x16x32_bf16 v[60:63], v[124:127], v[168:171], v[60:63]
  s_lshl_b32 s7, s7, 7
  ds_read_b64_tr_b16 v[112:113], v4 offset:49152
  s_waitcnt lgkmcnt(10)
  v_mfma_f32_16x16x32_bf16 v[64:67], v[128:131], v[164:167], v[64:67]
  ds_read_b64_tr_b16 v[114:115], v4 offset:50176
  v_add_u32 v183, s7, v13
  v_mfma_f32_16x16x32_bf16 v[68:71], v[128:131], v[168:171], v[68:71]
  buffer_load_dwordx4 a[8:11], v28, s[24:27], s50 offen offset:2048 sc1
  ds_read_b64_tr_b16 v[116:117], v5 offset:49152
  v_mfma_f32_16x16x32_bf16 v[72:75], v[132:135], v[164:167], v[72:75]
  ds_read_b64_tr_b16 v[118:119], v5 offset:50176
  v_and_b32 v201, 3, v2
  v_mfma_f32_16x16x32_bf16 v[76:79], v[132:135], v[168:171], v[76:79]
  ds_read_b64_tr_b16 v[120:121], v6 offset:49152
  s_waitcnt lgkmcnt(12)
  v_mfma_f32_16x16x32_bf16 v[80:83], v[136:139], v[164:167], v[80:83]
  ds_read_b64_tr_b16 v[122:123], v6 offset:50176
  v_lshl_add_u32 v200, v201, 3, v200
  v_mfma_f32_16x16x32_bf16 v[84:87], v[136:139], v[168:171], v[84:87]
  ds_read_b64_tr_b16 v[124:125], v7 offset:49152
  s_waitcnt lgkmcnt(9)
  v_mfma_f32_16x16x32_bf16 v[88:91], v[148:151], v[164:167], v[88:91]
  buffer_load_dwordx4 a[12:15], v28, s[24:27], s50 offen offset:3072 sc1
  ds_read_b64_tr_b16 v[126:127], v7 offset:50176
  v_mfma_f32_16x16x32_bf16 v[92:95], v[148:151], v[168:171], v[92:95]
  s_add_u32 s50, s97, 4096
  ds_read_b64_tr_b16 v[128:129], v8 offset:49152
  v_mfma_f32_16x16x32_bf16 v[104:107], v[140:143], v[152:155], v[104:107]
  s_lshl_b32 s10, s4, 11
  s_add_u32 s10, s10, 134400
  ds_read_b64_tr_b16 v[130:131], v8 offset:50176
  v_mfma_f32_16x16x32_bf16 v[108:111], v[144:147], v[152:155], v[108:111]
  ds_read_b64_tr_b16 v[132:133], v9 offset:49152
  v_add_u32 v200, s10, v200
  v_mfma_f32_16x16x32_bf16 v[96:99], v[164:167], v[164:167], v[96:99]
  buffer_load_dwordx4 a[16:19], v28, s[24:27], s50 offen offset:0 sc1
  ds_read_b64_tr_b16 v[134:135], v9 offset:50176
  v_mfma_f32_16x16x32_bf16 v[100:103], v[168:171], v[168:171], v[100:103]
  ds_read_b64_tr_b16 v[136:137], v10 offset:49152
  ds_read_b64_tr_b16 v[138:139], v10 offset:50176
  s_waitcnt lgkmcnt(10)
  v_mfma_f32_16x16x32_bf16 v[32:35], v[112:115], v[156:159], v[32:35]
  s_waitcnt vmcnt(8)
  ds_read_b64_tr_b16 v[140:141], v11 offset:49152
  ds_read_b64_tr_b16 v[204:205], v200 offset:0
  v_mfma_f32_16x16x32_bf16 v[36:39], v[112:115], v[160:163], v[36:39]
  ds_read_b64_tr_b16 v[142:143], v11 offset:50176
  ds_read_b64_tr_b16 v[206:207], v200 offset:256
  v_cndmask_b32 v233, v233, v234, s[90:91]
  v_mfma_f32_16x16x32_bf16 v[40:43], v[116:119], v[156:159], v[40:43]
  s_waitcnt vmcnt(10)
  ds_read_b64_tr_b16 v[144:145], v12 offset:49152
  ds_read_b64_tr_b16 v[208:209], v200 offset:32
  v_mfma_f32_16x16x32_bf16 v[44:47], v[116:119], v[160:163], v[44:47]
  ds_read_b64_tr_b16 v[146:147], v12 offset:50176
  ds_read_b64_tr_b16 v[210:211], v200 offset:288
  s_waitcnt lgkmcnt(14)
  v_mfma_f32_16x16x32_bf16 v[48:51], v[120:123], v[156:159], v[48:51]
  s_barrier
  ds_read_b128 v[148:151], v183 offset:0
  v_lshlrev_b32 v202, 12, v2
  v_mfma_f32_16x16x32_bf16 v[52:55], v[120:123], v[160:163], v[52:55]
  buffer_load_dwordx4 a[20:23], v28, s[24:27], s50 offen offset:1024 sc1
  ds_read_b128 v[164:167], v15 offset:49152
  v_mfma_f32_16x16x32_bf16 v[56:59], v[124:127], v[156:159], v[56:59]
  ds_read_b128 v[168:171], v15 offset:51200
  v_lshl_add_u32 v202, v3, 4, v202
  v_mfma_f32_16x16x32_bf16 v[60:63], v[124:127], v[160:163], v[60:63]
  s_lshl_b32 s10, s6, 17
  ds_read_b64_tr_b16 v[112:113], v4 offset:57344
  s_waitcnt lgkmcnt(14)
  v_mfma_f32_16x16x32_bf16 v[64:67], v[128:131], v[156:159], v[64:67]
  s_lshl_b32 s11, s5, 8
  s_add_u32 s10, s10, s11
  ds_read_b64_tr_b16 v[114:115], v4 offset:58368
  v_mfma_f32_16x16x32_bf16 v[68:71], v[128:131], v[160:163], v[68:71]
  buffer_load_dwordx4 a[24:27], v28, s[24:27], s50 offen offset:2048 sc1
  ds_read_b64_tr_b16 v[116:117], v5 offset:57344
  v_mfma_f32_16x16x32_bf16 v[72:75], v[132:135], v[156:159], v[72:75]
  s_lshl_b32 s11, s4, 6
  s_add_u32 s10, s10, s11
  ds_read_b64_tr_b16 v[118:119], v5 offset:58368
  v_mfma_f32_16x16x32_bf16 v[76:79], v[132:135], v[160:163], v[76:79]
  s_add_u32 s10, s10, 131072
  ds_read_b64_tr_b16 v[120:121], v6 offset:57344
  s_waitcnt lgkmcnt(15)
  v_mfma_f32_16x16x32_bf16 v[80:83], v[136:139], v[156:159], v[80:83]
  s_add_u32 s11, s10, 65536
  s_waitcnt lgkmcnt(8)
  ds_read_b64_tr_b16 v[122:123], v6 offset:58368
  v_mfma_f32_16x16x32_bf16 v[84:87], v[136:139], v[160:163], v[84:87]
  ds_read_b64_tr_b16 v[124:125], v7 offset:57344
  s_waitcnt lgkmcnt(9)
  v_mfma_f32_16x16x32_bf16 v[88:91], v[148:151], v[156:159], v[88:91]
  buffer_load_dwordx4 a[28:31], v28, s[24:27], s50 offen offset:3072 sc1
  ds_read_b64_tr_b16 v[126:127], v7 offset:58368
  v_mfma_f32_16x16x32_bf16 v[92:95], v[148:151], v[160:163], v[92:95]
  s_add_u32 s50, s97, 8192
  ds_read_b64_tr_b16 v[128:129], v8 offset:57344
  v_add_u32 v233, 4096, v233
  v_mfma_f32_16x16x32_bf16 v[104:107], v[140:143], v[152:155], v[104:107]
  buffer_store_dwordx4 v[204:207], v202, s[24:27], s10 offen sc1
  ds_read_b64_tr_b16 v[130:131], v8 offset:58368
  v_mfma_f32_16x16x32_bf16 v[108:111], v[144:147], v[152:155], v[108:111]
  ds_read_b64_tr_b16 v[132:133], v9 offset:57344
  v_accvgpr_write_b32 a240, v233
  v_mfma_f32_16x16x32_bf16 v[96:99], v[156:159], v[156:159], v[96:99]
  buffer_load_dwordx4 a[32:35], v28, s[24:27], s50 offen offset:0 sc1
  ds_read_b64_tr_b16 v[134:135], v9 offset:58368
  v_mfma_f32_16x16x32_bf16 v[100:103], v[160:163], v[160:163], v[100:103]
  ds_read_b64_tr_b16 v[136:137], v10 offset:57344
  ds_read_b64_tr_b16 v[138:139], v10 offset:58368
  s_waitcnt lgkmcnt(10)
  v_mfma_f32_16x16x32_bf16 v[32:35], v[112:115], v[164:167], v[32:35]
  buffer_store_dwordx4 v[208:211], v202, s[24:27], s11 offen sc1
  ds_read_b64_tr_b16 v[140:141], v11 offset:57344
  v_mfma_f32_16x16x32_bf16 v[36:39], v[112:115], v[168:171], v[36:39]
  ds_read_b64_tr_b16 v[142:143], v11 offset:58368
  v_mfma_f32_16x16x32_bf16 v[40:43], v[116:119], v[164:167], v[40:43]
  buffer_load_dwordx4 a[36:39], v28, s[24:27], s50 offen offset:1024 sc1
  ds_read_b64_tr_b16 v[144:145], v12 offset:57344
  v_mfma_f32_16x16x32_bf16 v[44:47], v[116:119], v[168:171], v[44:47]
  ds_read_b64_tr_b16 v[146:147], v12 offset:58368
  s_waitcnt lgkmcnt(10)
  v_mfma_f32_16x16x32_bf16 v[48:51], v[120:123], v[164:167], v[48:51]
  ds_read_b128 v[148:151], v183 offset:64
  v_mfma_f32_16x16x32_bf16 v[52:55], v[120:123], v[168:171], v[52:55]
  v_mfma_f32_16x16x32_bf16 v[56:59], v[124:127], v[164:167], v[56:59]
  buffer_load_dwordx4 a[40:43], v28, s[24:27], s50 offen offset:2048 sc1
  v_mfma_f32_16x16x32_bf16 v[60:63], v[124:127], v[168:171], v[60:63]
  s_waitcnt lgkmcnt(7)
  v_mfma_f32_16x16x32_bf16 v[64:67], v[128:131], v[164:167], v[64:67]
  v_mfma_f32_16x16x32_bf16 v[68:71], v[128:131], v[168:171], v[68:71]
  v_mfma_f32_16x16x32_bf16 v[72:75], v[132:135], v[164:167], v[72:75]
  buffer_load_dwordx4 a[44:47], v28, s[24:27], s50 offen offset:3072 sc1
  v_mfma_f32_16x16x32_bf16 v[76:79], v[132:135], v[168:171], v[76:79]
  s_waitcnt lgkmcnt(5)
  v_mfma_f32_16x16x32_bf16 v[80:83], v[136:139], v[164:167], v[80:83]
  v_mfma_f32_16x16x32_bf16 v[84:87], v[136:139], v[168:171], v[84:87]
  s_waitcnt lgkmcnt(0)
  v_mfma_f32_16x16x32_bf16 v[88:91], v[148:151], v[164:167], v[88:91]
  v_mfma_f32_16x16x32_bf16 v[92:95], v[148:151], v[168:171], v[92:95]
  v_mfma_f32_16x16x32_bf16 v[104:107], v[140:143], v[152:155], v[104:107]
  v_mfma_f32_16x16x32_bf16 v[108:111], v[144:147], v[152:155], v[108:111]
  v_mfma_f32_16x16x32_bf16 v[96:99], v[164:167], v[164:167], v[96:99]
  v_mfma_f32_16x16x32_bf16 v[100:103], v[168:171], v[168:171], v[100:103]
  v_cmp_eq_u32 vcc, 0, v2
  s_lshl_b32 s3, s4, 7
  s_add_u32 s3, s3, 142592
  v_lshl_add_u32 v184, v3, 4, s3
  v_and_b32 v185, 3, v2
  v_cmp_eq_u32 s[78:79], 1, v185
  v_cmp_eq_u32 s[80:81], 2, v185
  v_cmp_eq_u32 s[82:83], 3, v185
  v_lshrrev_b32 v186, 2, v2
  v_lshl_add_u32 v186, v186, 4, v2
  v_lshlrev_b32 v186, 2, v186
  s_and_saveexec_b64 s[74:75], vcc
  ds_write_b128 v184, v[104:107]
  ds_write_b128 v184, v[108:111] offset:64
  s_mov_b64 exec, s[74:75]
  v_cndmask_b32 v187, v96, v97, s[78:79]
  v_cndmask_b32 v187, v187, v98, s[80:81]
  s_add_u32 s50, s97, 12288
  buffer_load_dwordx4 a[48:51], v28, s[24:27], s50 offen offset:0 sc1
  v_cndmask_b32 v187, v187, v99, s[82:83]
  v_cndmask_b32 v188, v100, v101, s[78:79]
  v_cndmask_b32 v188, v188, v102, s[80:81]
  v_cndmask_b32 v188, v188, v103, s[82:83]
  ds_bpermute_b32 v189, v186, v187
  ds_bpermute_b32 v190, v186, v188
  s_waitcnt lgkmcnt(0)
  s_barrier
  v_lshlrev_b32 v185, 4, v3
  v_add_u32 v185, 142592, v185
  ds_read_b128 v[112:115], v185 offset:0
  ds_read_b128 v[140:143], v185 offset:512
  ds_read_b128 v[116:119], v185 offset:64
  buffer_load_dwordx4 a[52:55], v28, s[24:27], s50 offen offset:1024 sc1
  ds_read_b128 v[144:147], v185 offset:576
  ds_read_b128 v[120:123], v185 offset:128
  ds_read_b128 v[148:151], v185 offset:640
  ds_read_b128 v[124:127], v185 offset:192
  ds_read_b128 v[152:155], v185 offset:704
  ds_read_b128 v[128:131], v185 offset:256
  ds_read_b128 v[156:159], v185 offset:768
  ds_read_b128 v[132:135], v185 offset:320
  ds_read_b128 v[160:163], v185 offset:832
  ds_read_b128 v[136:139], v185 offset:384
  ds_read_b128 v[164:167], v185 offset:896
  v_mul_f32 v192, 0x3b000000, v88
  v_mul_f32 v193, 0x3b000000, v92
  buffer_load_dwordx4 a[56:59], v28, s[24:27], s50 offen offset:2048 sc1
  v_mul_f32 v194, 0x3b000000, v189
  v_mul_f32 v195, 0x3b000000, v190
  v_cvt_pk_bf16_f32 v198, v89, v89
  v_cvt_pk_bf16_f32 v199, v93, v93
  v_fma_f32 v194, -v192, v192, v194
  v_fma_f32 v195, -v193, v193, v195
  v_and_b32 v198, 0xffff0000, v198
  v_and_b32 v199, 0xffff0000, v199
  v_max_f32 v194, 0, v194
  v_max_f32 v195, 0, v195
  v_mul_f32 v198, 0xbfb8aa3b, v198
  v_mul_f32 v199, 0xbfb8aa3b, v199
  v_cvt_pk_bf16_f32 v196, v192, v194
  buffer_load_dwordx4 a[60:63], v28, s[24:27], s50 offen offset:3072 sc1
  v_cvt_pk_bf16_f32 v197, v193, v195
  v_exp_f32 v198, v198
  v_exp_f32 v199, v199
  v_lshlrev_b32 v192, 16, v196
  v_lshlrev_b32 v193, 16, v197
  v_and_b32 v194, 0xffff0000, v196
  v_and_b32 v195, 0xffff0000, v197
  v_add_f32 v198, 1.0, v198
  v_add_f32 v199, 1.0, v199
  v_add_f32 v194, 0x3727c5ac, v194
  v_add_f32 v195, 0x3727c5ac, v195
  v_rcp_f32 v198, v198
  v_rcp_f32 v199, v199
  s_add_u32 s50, s97, 16384
  buffer_load_dwordx4 a[64:67], v28, s[24:27], s50 offen offset:0 sc1
  v_cvt_pk_bf16_f32 v196, v194, v194
  v_cvt_pk_bf16_f32 v197, v195, v195
  v_and_b32 v194, 0xffff0000, v196
  v_and_b32 v195, 0xffff0000, v197
  v_cvt_pk_bf16_f32 v198, v198, v198
  v_cvt_pk_bf16_f32 v199, v199, v199
  v_sqrt_f32 v194, v194
  v_sqrt_f32 v195, v195
  v_and_b32 v204, 0xffff0000, v198
  v_and_b32 v205, 0xffff0000, v199
  v_cvt_pk_bf16_f32 v196, v194, v194
  v_cvt_pk_bf16_f32 v197, v195, v195
  v_and_b32 v194, 0xffff0000, v196
  buffer_load_dwordx4 a[68:71], v28, s[24:27], s50 offen offset:1024 sc1
  v_and_b32 v195, 0xffff0000, v197
  v_rcp_f32 v200, v194
  v_rcp_f32 v201, v195
  v_mul_f32 v202, -v192, v200
  v_mul_f32 v203, -v193, v201
  s_cmp_lg_u32 s6, 0
  s_cbranch_scc1 L_nogate
  s_lshl_b32 s3, s5, 2
  s_add_u32 s3, s3, s4
  s_lshl_b32 s3, s3, 7
  s_add_u32 s3, s3, 114688
  v_cmp_eq_u32 vcc, 1, v3
  v_lshlrev_b32 v185, 2, v1
  s_nop 0
  v_cndmask_b32 v186, v204, v205, vcc
  s_mov_b64 s[74:75], exec
  s_mov_b32 exec_hi, 0
  buffer_store_dword v186, v185, s[24:27], s3 offen sc1
  s_mov_b64 exec, s[74:75]
L_nogate:
  v_mov_b32 v206, 0xc0135761
  v_mov_b32 v207, 0xc0135761
  v_mov_b32 v208, 1.0
  v_mov_b32 v209, 1.0
  s_mov_b32 s76, 0xbdd2d3e8
  s_mov_b32 s77, 0xbdd2d3e8
  s_lshl_b32 s3, s5, 3
  s_lshl_b32 s10, s4, 1
  s_add_u32 s3, s3, s10
  s_lshl_b32 s3, s3, 3
  s_lshr_b32 s10, s6, 1
  s_add_u32 s3, s3, s10
  s_mul_i32 s3, s3, 7168
  s_add_u32 s3, s3, 4325376
  s_and_b32 s10, s6, 1
  s_mul_i32 s11, s10, 3072
  s_add_u32 s86, s3, s11
  s_add_u32 s87, s86, 57344
  s_lshl_b32 s11, s10, 9
  s_add_u32 s88, s3, s11
  s_add_u32 s88, s88, 6144
  s_add_u32 s89, s88, 57344
  v_lshlrev_b32 v210, 4, v1
  v_lshlrev_b32 v211, 3, v1
  s_waitcnt lgkmcnt(0)
  v_pk_fma_f32 v[212:213], v[112:113], v[202:203], v[140:141] op_sel:[0,0,0] op_sel_hi:[1,0,1]
  v_pk_fma_f32 v[218:219], v[114:115], v[202:203], v[142:143] op_sel:[0,0,0] op_sel_hi:[1,0,1]
  v_pk_fma_f32 v[224:225], v[116:117], v[202:203], v[144:145] op_sel:[0,0,0] op_sel_hi:[1,0,1]
  v_pk_fma_f32 v[230:231], v[118:119], v[202:203], v[146:147] op_sel:[0,0,0] op_sel_hi:[1,0,1]
  v_pk_fma_f32 v[212:213], v[32:33], v[200:201], v[212:213] op_sel:[0,0,0] op_sel_hi:[1,0,1]
  v_pk_fma_f32 v[218:219], v[34:35], v[200:201], v[218:219] op_sel:[0,0,0] op_sel_hi:[1,0,1]
  v_pk_fma_f32 v[224:225], v[40:41], v[200:201], v[224:225] op_sel:[0,0,0] op_sel_hi:[1,0,1]
  v_pk_fma_f32 v[230:231], v[42:43], v[200:201], v[230:231] op_sel:[0,0,0] op_sel_hi:[1,0,1]
  v_pk_mul_f32 v[214:215], v[212:213], v[212:213]
  v_pk_mul_f32 v[220:221], v[218:219], v[218:219]
  v_pk_mul_f32 v[226:227], v[224:225], v[224:225]
  v_pk_mul_f32 v[232:233], v[230:231], v[230:231]
  v_pk_fma_f32 v[214:215], v[214:215], s[76:77], v[206:207]
  v_pk_fma_f32 v[220:221], v[220:221], s[76:77], v[206:207]
  v_pk_fma_f32 v[226:227], v[226:227], s[76:77], v[206:207]
  v_pk_fma_f32 v[232:233], v[232:233], s[76:77], v[206:207]
  v_pk_mul_f32 v[214:215], v[214:215], v[212:213]
  v_pk_mul_f32 v[220:221], v[220:221], v[218:219]
  v_pk_mul_f32 v[226:227], v[226:227], v[224:225]
  v_pk_mul_f32 v[232:233], v[232:233], v[230:231]
  v_exp_f32 v214, v214
  v_exp_f32 v215, v215
  v_exp_f32 v220, v220
  v_exp_f32 v221, v221
  v_exp_f32 v226, v226
  v_exp_f32 v227, v227
  v_exp_f32 v232, v232
  v_exp_f32 v233, v233
  v_pk_add_f32 v[214:215], v[214:215], v[208:209]
  v_pk_add_f32 v[220:221], v[220:221], v[208:209]
  v_pk_add_f32 v[226:227], v[226:227], v[208:209]
  v_pk_add_f32 v[232:233], v[232:233], v[208:209]
  v_rcp_f32 v214, v214
  v_rcp_f32 v215, v215
  v_rcp_f32 v220, v220
  v_rcp_f32 v221, v221
  v_rcp_f32 v226, v226
  v_rcp_f32 v227, v227
  v_rcp_f32 v232, v232
  v_rcp_f32 v233, v233
  v_pk_mul_f32 v[212:213], v[212:213], v[214:215]
  v_pk_mul_f32 v[218:219], v[218:219], v[220:221]
  v_pk_mul_f32 v[224:225], v[224:225], v[226:227]
  v_pk_mul_f32 v[230:231], v[230:231], v[232:233]
  v_cvt_pk_bf16_f32 v240, v212, v213
  v_cvt_pk_bf16_f32 v241, v218, v219
  v_cvt_pk_bf16_f32 v242, v224, v225
  v_cvt_pk_bf16_f32 v243, v230, v231
  buffer_store_dwordx4 v[240:243], v210, s[24:27], s86 offen offset:0 sc1
  v_pk_fma_f32 v[212:213], v[120:121], v[202:203], v[148:149] op_sel:[0,0,0] op_sel_hi:[1,0,1]
  v_pk_fma_f32 v[218:219], v[122:123], v[202:203], v[150:151] op_sel:[0,0,0] op_sel_hi:[1,0,1]
  v_pk_fma_f32 v[224:225], v[124:125], v[202:203], v[152:153] op_sel:[0,0,0] op_sel_hi:[1,0,1]
  v_pk_fma_f32 v[230:231], v[126:127], v[202:203], v[154:155] op_sel:[0,0,0] op_sel_hi:[1,0,1]
  v_pk_fma_f32 v[212:213], v[48:49], v[200:201], v[212:213] op_sel:[0,0,0] op_sel_hi:[1,0,1]
  v_pk_fma_f32 v[218:219], v[50:51], v[200:201], v[218:219] op_sel:[0,0,0] op_sel_hi:[1,0,1]
  v_pk_fma_f32 v[224:225], v[56:57], v[200:201], v[224:225] op_sel:[0,0,0] op_sel_hi:[1,0,1]
  v_pk_fma_f32 v[230:231], v[58:59], v[200:201], v[230:231] op_sel:[0,0,0] op_sel_hi:[1,0,1]
  v_pk_mul_f32 v[214:215], v[212:213], v[212:213]
  v_pk_mul_f32 v[220:221], v[218:219], v[218:219]
  v_pk_mul_f32 v[226:227], v[224:225], v[224:225]
  v_pk_mul_f32 v[232:233], v[230:231], v[230:231]
  v_pk_fma_f32 v[214:215], v[214:215], s[76:77], v[206:207]
  v_pk_fma_f32 v[220:221], v[220:221], s[76:77], v[206:207]
  v_pk_fma_f32 v[226:227], v[226:227], s[76:77], v[206:207]
  v_pk_fma_f32 v[232:233], v[232:233], s[76:77], v[206:207]
  buffer_load_dwordx4 a[72:75], v28, s[24:27], s50 offen offset:2048 sc1
  v_pk_mul_f32 v[214:215], v[214:215], v[212:213]
  v_pk_mul_f32 v[220:221], v[220:221], v[218:219]
  v_pk_mul_f32 v[226:227], v[226:227], v[224:225]
  v_pk_mul_f32 v[232:233], v[232:233], v[230:231]
  v_exp_f32 v214, v214
  v_exp_f32 v215, v215
  v_exp_f32 v220, v220
  v_exp_f32 v221, v221
  v_exp_f32 v226, v226
  v_exp_f32 v227, v227
  v_exp_f32 v232, v232
  v_exp_f32 v233, v233
  v_pk_add_f32 v[214:215], v[214:215], v[208:209]
  v_pk_add_f32 v[220:221], v[220:221], v[208:209]
  v_pk_add_f32 v[226:227], v[226:227], v[208:209]
  v_pk_add_f32 v[232:233], v[232:233], v[208:209]
  v_rcp_f32 v214, v214
  v_rcp_f32 v215, v215
  v_rcp_f32 v220, v220
  v_rcp_f32 v221, v221
  v_rcp_f32 v226, v226
  v_rcp_f32 v227, v227
  v_rcp_f32 v232, v232
  v_rcp_f32 v233, v233
  v_pk_mul_f32 v[212:213], v[212:213], v[214:215]
  v_pk_mul_f32 v[218:219], v[218:219], v[220:221]
  v_pk_mul_f32 v[224:225], v[224:225], v[226:227]
  v_pk_mul_f32 v[230:231], v[230:231], v[232:233]
  v_cvt_pk_bf16_f32 v244, v212, v213
  v_cvt_pk_bf16_f32 v245, v218, v219
  v_cvt_pk_bf16_f32 v246, v224, v225
  v_cvt_pk_bf16_f32 v247, v230, v231
  buffer_store_dwordx4 v[244:247], v210, s[24:27], s86 offen offset:1024 sc1
  v_pk_fma_f32 v[212:213], v[128:129], v[202:203], v[156:157] op_sel:[0,0,0] op_sel_hi:[1,0,1]
  v_pk_fma_f32 v[218:219], v[130:131], v[202:203], v[158:159] op_sel:[0,0,0] op_sel_hi:[1,0,1]
  v_pk_fma_f32 v[224:225], v[132:133], v[202:203], v[160:161] op_sel:[0,0,0] op_sel_hi:[1,0,1]
  v_pk_fma_f32 v[230:231], v[134:135], v[202:203], v[162:163] op_sel:[0,0,0] op_sel_hi:[1,0,1]
  v_pk_fma_f32 v[212:213], v[64:65], v[200:201], v[212:213] op_sel:[0,0,0] op_sel_hi:[1,0,1]
  v_pk_fma_f32 v[218:219], v[66:67], v[200:201], v[218:219] op_sel:[0,0,0] op_sel_hi:[1,0,1]
  v_pk_fma_f32 v[224:225], v[72:73], v[200:201], v[224:225] op_sel:[0,0,0] op_sel_hi:[1,0,1]
  v_pk_fma_f32 v[230:231], v[74:75], v[200:201], v[230:231] op_sel:[0,0,0] op_sel_hi:[1,0,1]
  v_pk_mul_f32 v[214:215], v[212:213], v[212:213]
  v_pk_mul_f32 v[220:221], v[218:219], v[218:219]
  v_pk_mul_f32 v[226:227], v[224:225], v[224:225]
  v_pk_mul_f32 v[232:233], v[230:231], v[230:231]
  v_pk_fma_f32 v[214:215], v[214:215], s[76:77], v[206:207]
  v_pk_fma_f32 v[220:221], v[220:221], s[76:77], v[206:207]
  v_pk_fma_f32 v[226:227], v[226:227], s[76:77], v[206:207]
  v_pk_fma_f32 v[232:233], v[232:233], s[76:77], v[206:207]
  v_pk_mul_f32 v[214:215], v[214:215], v[212:213]
  v_pk_mul_f32 v[220:221], v[220:221], v[218:219]
  v_pk_mul_f32 v[226:227], v[226:227], v[224:225]
  v_pk_mul_f32 v[232:233], v[232:233], v[230:231]
  v_exp_f32 v214, v214
  v_exp_f32 v215, v215
  v_exp_f32 v220, v220
  v_exp_f32 v221, v221
  v_exp_f32 v226, v226
  v_exp_f32 v227, v227
  v_exp_f32 v232, v232
  v_exp_f32 v233, v233
  v_pk_add_f32 v[214:215], v[214:215], v[208:209]
  v_pk_add_f32 v[220:221], v[220:221], v[208:209]
  v_pk_add_f32 v[226:227], v[226:227], v[208:209]
  v_pk_add_f32 v[232:233], v[232:233], v[208:209]
  buffer_load_dwordx4 a[76:79], v28, s[24:27], s50 offen offset:3072 sc1
  v_rcp_f32 v214, v214
  v_rcp_f32 v215, v215
  v_rcp_f32 v220, v220
  v_rcp_f32 v221, v221
  v_rcp_f32 v226, v226
  v_rcp_f32 v227, v227
  v_rcp_f32 v232, v232
  v_rcp_f32 v233, v233
  v_pk_mul_f32 v[212:213], v[212:213], v[214:215]
  v_pk_mul_f32 v[218:219], v[218:219], v[220:221]
  v_pk_mul_f32 v[224:225], v[224:225], v[226:227]
  v_pk_mul_f32 v[230:231], v[230:231], v[232:233]
  v_cvt_pk_bf16_f32 v240, v212, v213
  v_cvt_pk_bf16_f32 v241, v218, v219
  v_cvt_pk_bf16_f32 v242, v224, v225
  v_cvt_pk_bf16_f32 v243, v230, v231
  buffer_store_dwordx4 v[240:243], v210, s[24:27], s86 offen offset:2048 sc1
  v_pk_fma_f32 v[212:213], v[136:137], v[202:203], v[164:165] op_sel:[0,0,0] op_sel_hi:[1,0,1]
  v_pk_fma_f32 v[218:219], v[138:139], v[202:203], v[166:167] op_sel:[0,0,0] op_sel_hi:[1,0,1]
  v_pk_fma_f32 v[212:213], v[80:81], v[200:201], v[212:213] op_sel:[0,0,0] op_sel_hi:[1,0,1]
  v_pk_fma_f32 v[218:219], v[82:83], v[200:201], v[218:219] op_sel:[0,0,0] op_sel_hi:[1,0,1]
  v_pk_mul_f32 v[214:215], v[212:213], v[212:213]
  v_pk_mul_f32 v[220:221], v[218:219], v[218:219]
  v_pk_fma_f32 v[214:215], v[214:215], s[76:77], v[206:207]
  v_pk_fma_f32 v[220:221], v[220:221], s[76:77], v[206:207]
  v_pk_mul_f32 v[214:215], v[214:215], v[212:213]
  v_pk_mul_f32 v[220:221], v[220:221], v[218:219]
  v_exp_f32 v214, v214
  v_exp_f32 v215, v215
  v_exp_f32 v220, v220
  v_exp_f32 v221, v221
  v_pk_add_f32 v[214:215], v[214:215], v[208:209]
  v_pk_add_f32 v[220:221], v[220:221], v[208:209]
  v_rcp_f32 v214, v214
  v_rcp_f32 v215, v215
  v_rcp_f32 v220, v220
  v_rcp_f32 v221, v221
  v_pk_mul_f32 v[212:213], v[212:213], v[214:215]
  v_pk_mul_f32 v[218:219], v[218:219], v[220:221]
  v_cvt_pk_bf16_f32 v244, v212, v213
  v_cvt_pk_bf16_f32 v245, v218, v219
  buffer_store_dwordx2 v[244:245], v211, s[24:27], s88 offen sc1
  v_pk_fma_f32 v[212:213], v[112:113], v[202:203], v[140:141] op_sel:[0,1,0] op_sel_hi:[1,1,1]
  v_pk_fma_f32 v[218:219], v[114:115], v[202:203], v[142:143] op_sel:[0,1,0] op_sel_hi:[1,1,1]
  v_pk_fma_f32 v[224:225], v[116:117], v[202:203], v[144:145] op_sel:[0,1,0] op_sel_hi:[1,1,1]
  v_pk_fma_f32 v[230:231], v[118:119], v[202:203], v[146:147] op_sel:[0,1,0] op_sel_hi:[1,1,1]
  v_pk_fma_f32 v[212:213], v[36:37], v[200:201], v[212:213] op_sel:[0,1,0] op_sel_hi:[1,1,1]
  v_pk_fma_f32 v[218:219], v[38:39], v[200:201], v[218:219] op_sel:[0,1,0] op_sel_hi:[1,1,1]
  v_pk_fma_f32 v[224:225], v[44:45], v[200:201], v[224:225] op_sel:[0,1,0] op_sel_hi:[1,1,1]
  v_pk_fma_f32 v[230:231], v[46:47], v[200:201], v[230:231] op_sel:[0,1,0] op_sel_hi:[1,1,1]
  v_pk_mul_f32 v[214:215], v[212:213], v[212:213]
  v_pk_mul_f32 v[220:221], v[218:219], v[218:219]
  v_pk_mul_f32 v[226:227], v[224:225], v[224:225]
  v_pk_mul_f32 v[232:233], v[230:231], v[230:231]
  v_pk_fma_f32 v[214:215], v[214:215], s[76:77], v[206:207]
  v_pk_fma_f32 v[220:221], v[220:221], s[76:77], v[206:207]
  v_pk_fma_f32 v[226:227], v[226:227], s[76:77], v[206:207]
  v_pk_fma_f32 v[232:233], v[232:233], s[76:77], v[206:207]
  v_pk_mul_f32 v[214:215], v[214:215], v[212:213]
  v_pk_mul_f32 v[220:221], v[220:221], v[218:219]
  v_pk_mul_f32 v[226:227], v[226:227], v[224:225]
  v_pk_mul_f32 v[232:233], v[232:233], v[230:231]
  v_exp_f32 v214, v214
  v_exp_f32 v215, v215
  v_exp_f32 v220, v220
  v_exp_f32 v221, v221
  s_add_u32 s50, s97, 20480
  buffer_load_dwordx4 a[80:83], v28, s[24:27], s50 offen offset:0 sc1
  v_exp_f32 v226, v226
  v_exp_f32 v227, v227
  v_exp_f32 v232, v232
  v_exp_f32 v233, v233
  v_pk_add_f32 v[214:215], v[214:215], v[208:209]
  v_pk_add_f32 v[220:221], v[220:221], v[208:209]
  v_pk_add_f32 v[226:227], v[226:227], v[208:209]
  v_pk_add_f32 v[232:233], v[232:233], v[208:209]
  v_rcp_f32 v214, v214
  v_rcp_f32 v215, v215
  v_rcp_f32 v220, v220
  v_rcp_f32 v221, v221
  v_rcp_f32 v226, v226
  v_rcp_f32 v227, v227
  v_rcp_f32 v232, v232
  v_rcp_f32 v233, v233
  v_pk_mul_f32 v[212:213], v[212:213], v[214:215]
  v_pk_mul_f32 v[218:219], v[218:219], v[220:221]
  v_pk_mul_f32 v[224:225], v[224:225], v[226:227]
  v_pk_mul_f32 v[230:231], v[230:231], v[232:233]
  v_cvt_pk_bf16_f32 v240, v212, v213
  v_cvt_pk_bf16_f32 v241, v218, v219
  v_cvt_pk_bf16_f32 v242, v224, v225
  v_cvt_pk_bf16_f32 v243, v230, v231
  buffer_store_dwordx4 v[240:243], v210, s[24:27], s87 offen offset:0 sc1
  v_pk_fma_f32 v[212:213], v[120:121], v[202:203], v[148:149] op_sel:[0,1,0] op_sel_hi:[1,1,1]
  v_pk_fma_f32 v[218:219], v[122:123], v[202:203], v[150:151] op_sel:[0,1,0] op_sel_hi:[1,1,1]
  v_pk_fma_f32 v[224:225], v[124:125], v[202:203], v[152:153] op_sel:[0,1,0] op_sel_hi:[1,1,1]
  v_pk_fma_f32 v[230:231], v[126:127], v[202:203], v[154:155] op_sel:[0,1,0] op_sel_hi:[1,1,1]
  v_pk_fma_f32 v[212:213], v[52:53], v[200:201], v[212:213] op_sel:[0,1,0] op_sel_hi:[1,1,1]
  v_pk_fma_f32 v[218:219], v[54:55], v[200:201], v[218:219] op_sel:[0,1,0] op_sel_hi:[1,1,1]
  v_pk_fma_f32 v[224:225], v[60:61], v[200:201], v[224:225] op_sel:[0,1,0] op_sel_hi:[1,1,1]
  v_pk_fma_f32 v[230:231], v[62:63], v[200:201], v[230:231] op_sel:[0,1,0] op_sel_hi:[1,1,1]
  v_pk_mul_f32 v[214:215], v[212:213], v[212:213]
  v_pk_mul_f32 v[220:221], v[218:219], v[218:219]
  v_pk_mul_f32 v[226:227], v[224:225], v[224:225]
  v_pk_mul_f32 v[232:233], v[230:231], v[230:231]
  v_pk_fma_f32 v[214:215], v[214:215], s[76:77], v[206:207]
  v_pk_fma_f32 v[220:221], v[220:221], s[76:77], v[206:207]
  v_pk_fma_f32 v[226:227], v[226:227], s[76:77], v[206:207]
  v_pk_fma_f32 v[232:233], v[232:233], s[76:77], v[206:207]
  v_pk_mul_f32 v[214:215], v[214:215], v[212:213]
  v_pk_mul_f32 v[220:221], v[220:221], v[218:219]
  v_pk_mul_f32 v[226:227], v[226:227], v[224:225]
  v_pk_mul_f32 v[232:233], v[232:233], v[230:231]
  v_exp_f32 v214, v214
  v_exp_f32 v215, v215
  v_exp_f32 v220, v220
  v_exp_f32 v221, v221
  v_exp_f32 v226, v226
  v_exp_f32 v227, v227
  v_exp_f32 v232, v232
  v_exp_f32 v233, v233
  v_pk_add_f32 v[214:215], v[214:215], v[208:209]
  v_pk_add_f32 v[220:221], v[220:221], v[208:209]
  v_pk_add_f32 v[226:227], v[226:227], v[208:209]
  v_pk_add_f32 v[232:233], v[232:233], v[208:209]
  v_rcp_f32 v214, v214
  v_rcp_f32 v215, v215
  v_rcp_f32 v220, v220
  v_rcp_f32 v221, v221
  v_rcp_f32 v226, v226
  v_rcp_f32 v227, v227
  v_rcp_f32 v232, v232
  v_rcp_f32 v233, v233
  buffer_load_dwordx4 a[84:87], v28, s[24:27], s50 offen offset:1024 sc1
  v_pk_mul_f32 v[212:213], v[212:213], v[214:215]
  v_pk_mul_f32 v[218:219], v[218:219], v[220:221]
  v_pk_mul_f32 v[224:225], v[224:225], v[226:227]
  v_pk_mul_f32 v[230:231], v[230:231], v[232:233]
  v_cvt_pk_bf16_f32 v244, v212, v213
  v_cvt_pk_bf16_f32 v245, v218, v219
  v_cvt_pk_bf16_f32 v246, v224, v225
  v_cvt_pk_bf16_f32 v247, v230, v231
  buffer_store_dwordx4 v[244:247], v210, s[24:27], s87 offen offset:1024 sc1
  v_pk_fma_f32 v[212:213], v[128:129], v[202:203], v[156:157] op_sel:[0,1,0] op_sel_hi:[1,1,1]
  v_pk_fma_f32 v[218:219], v[130:131], v[202:203], v[158:159] op_sel:[0,1,0] op_sel_hi:[1,1,1]
  v_pk_fma_f32 v[224:225], v[132:133], v[202:203], v[160:161] op_sel:[0,1,0] op_sel_hi:[1,1,1]
  v_pk_fma_f32 v[230:231], v[134:135], v[202:203], v[162:163] op_sel:[0,1,0] op_sel_hi:[1,1,1]
  v_pk_fma_f32 v[212:213], v[68:69], v[200:201], v[212:213] op_sel:[0,1,0] op_sel_hi:[1,1,1]
  v_pk_fma_f32 v[218:219], v[70:71], v[200:201], v[218:219] op_sel:[0,1,0] op_sel_hi:[1,1,1]
  v_pk_fma_f32 v[224:225], v[76:77], v[200:201], v[224:225] op_sel:[0,1,0] op_sel_hi:[1,1,1]
  v_pk_fma_f32 v[230:231], v[78:79], v[200:201], v[230:231] op_sel:[0,1,0] op_sel_hi:[1,1,1]
  v_pk_mul_f32 v[214:215], v[212:213], v[212:213]
  v_pk_mul_f32 v[220:221], v[218:219], v[218:219]
  v_pk_mul_f32 v[226:227], v[224:225], v[224:225]
  v_pk_mul_f32 v[232:233], v[230:231], v[230:231]
  v_pk_fma_f32 v[214:215], v[214:215], s[76:77], v[206:207]
  v_pk_fma_f32 v[220:221], v[220:221], s[76:77], v[206:207]
  v_pk_fma_f32 v[226:227], v[226:227], s[76:77], v[206:207]
  v_pk_fma_f32 v[232:233], v[232:233], s[76:77], v[206:207]
  v_pk_mul_f32 v[214:215], v[214:215], v[212:213]
  v_pk_mul_f32 v[220:221], v[220:221], v[218:219]
  v_pk_mul_f32 v[226:227], v[226:227], v[224:225]
  v_pk_mul_f32 v[232:233], v[232:233], v[230:231]
  v_exp_f32 v214, v214
  v_exp_f32 v215, v215
  v_exp_f32 v220, v220
  v_exp_f32 v221, v221
  v_exp_f32 v226, v226
  v_exp_f32 v227, v227
  v_exp_f32 v232, v232
  v_exp_f32 v233, v233
  v_pk_add_f32 v[214:215], v[214:215], v[208:209]
  v_pk_add_f32 v[220:221], v[220:221], v[208:209]
  v_pk_add_f32 v[226:227], v[226:227], v[208:209]
  v_pk_add_f32 v[232:233], v[232:233], v[208:209]
  v_rcp_f32 v214, v214
  v_rcp_f32 v215, v215
  v_rcp_f32 v220, v220
  v_rcp_f32 v221, v221
  v_rcp_f32 v226, v226
  v_rcp_f32 v227, v227
  v_rcp_f32 v232, v232
  v_rcp_f32 v233, v233
  v_pk_mul_f32 v[212:213], v[212:213], v[214:215]
  v_pk_mul_f32 v[218:219], v[218:219], v[220:221]
  v_pk_mul_f32 v[224:225], v[224:225], v[226:227]
  v_pk_mul_f32 v[230:231], v[230:231], v[232:233]
  v_cvt_pk_bf16_f32 v240, v212, v213
  v_cvt_pk_bf16_f32 v241, v218, v219
  v_cvt_pk_bf16_f32 v242, v224, v225
  v_cvt_pk_bf16_f32 v243, v230, v231
  buffer_store_dwordx4 v[240:243], v210, s[24:27], s87 offen offset:2048 sc1
  v_pk_fma_f32 v[212:213], v[136:137], v[202:203], v[164:165] op_sel:[0,1,0] op_sel_hi:[1,1,1]
  v_pk_fma_f32 v[218:219], v[138:139], v[202:203], v[166:167] op_sel:[0,1,0] op_sel_hi:[1,1,1]
  v_pk_fma_f32 v[212:213], v[84:85], v[200:201], v[212:213] op_sel:[0,1,0] op_sel_hi:[1,1,1]
  v_pk_fma_f32 v[218:219], v[86:87], v[200:201], v[218:219] op_sel:[0,1,0] op_sel_hi:[1,1,1]
  v_pk_mul_f32 v[214:215], v[212:213], v[212:213]
  v_pk_mul_f32 v[220:221], v[218:219], v[218:219]
  v_pk_fma_f32 v[214:215], v[214:215], s[76:77], v[206:207]
  v_pk_fma_f32 v[220:221], v[220:221], s[76:77], v[206:207]
  buffer_load_dwordx4 a[88:91], v28, s[24:27], s50 offen offset:2048 sc1
  v_pk_mul_f32 v[214:215], v[214:215], v[212:213]
  v_pk_mul_f32 v[220:221], v[220:221], v[218:219]
  v_exp_f32 v214, v214
  v_exp_f32 v215, v215
  v_exp_f32 v220, v220
  v_exp_f32 v221, v221
  v_pk_add_f32 v[214:215], v[214:215], v[208:209]
  v_pk_add_f32 v[220:221], v[220:221], v[208:209]
  v_rcp_f32 v214, v214
  v_rcp_f32 v215, v215
  v_rcp_f32 v220, v220
  v_rcp_f32 v221, v221
  v_pk_mul_f32 v[212:213], v[212:213], v[214:215]
  v_pk_mul_f32 v[218:219], v[218:219], v[220:221]
  v_cvt_pk_bf16_f32 v244, v212, v213
  v_cvt_pk_bf16_f32 v245, v218, v219
  buffer_store_dwordx2 v[244:245], v211, s[24:27], s89 offen sc1
  s_waitcnt vmcnt(48)
  s_lshr_b32 s3, s4, 1
  s_mul_i32 s3, s3, 17408
  s_and_b32 s10, s4, 1
  s_lshl_b32 s10, s10, 8
  s_add_u32 s3, s3, s10
  v_lshl_add_u32 v198, v1, 2, s3
  v_lshlrev_b32 v16, 16, v16
  v_lshlrev_b32 v17, 16, v17
  v_lshlrev_b32 v18, 16, v18
  v_lshlrev_b32 v19, 16, v19
  v_lshlrev_b32 v20, 16, v20
  v_lshlrev_b32 v21, 16, v21
  v_lshlrev_b32 v22, 16, v22
  v_mul_f32 v200, 0x3fb8aa3b, v22
  v_exp_f32 v200, v200
  s_nop 0
  v_cvt_pk_bf16_f32 v200, v200, v200
  v_and_b32 v200, 0xffff0000, v200
  v_mul_f32 v201, v200, v16
  v_mul_f32 v202, v200, v17
  v_mul_f32 v18, v200, v18
  v_mul_f32 v19, v200, v19
  v_mul_f32 v201, 0x3fb8aa3b, v201
  v_mul_f32 v202, 0x3e22f983, v202
  v_mul_f32 v204, v20, v18
  v_mul_f32 v205, v20, v19
  v_fma_f32 v204, -v21, v19, v204
  buffer_load_dwordx4 a[92:95], v28, s[24:27], s50 offen offset:3072 sc1
  v_fma_f32 v205, v21, v18, v205
  v_mul_f32 v216, 0x3f800000, v201
  v_mul_f32 v217, 0x3f800000, v202
  v_mul_f32 v218, 0x41000000, v201
  v_mul_f32 v219, 0x41000000, v202
  v_mul_f32 v220, 0x43800000, v201
  v_mul_f32 v221, 0x43800000, v202
  v_exp_f32 v216, v216
  v_fract_f32 v217, v217
  v_exp_f32 v218, v218
  v_fract_f32 v219, v219
  v_exp_f32 v220, v220
  v_fract_f32 v221, v221
  v_cos_f32 v206, v217
  v_sin_f32 v207, v217
  v_cos_f32 v212, v219
  v_sin_f32 v213, v219
  v_cos_f32 v214, v221
  v_sin_f32 v215, v221
  v_mul_f32 v206, v216, v206
  s_add_u32 s50, s97, 24576
  buffer_load_dwordx4 a[96:99], v28, s[24:27], s50 offen offset:0 sc1
  v_mul_f32 v207, v216, v207
  v_mul_f32 v212, v218, v212
  v_mul_f32 v213, v218, v213
  v_mul_f32 v214, v220, v214
  v_mul_f32 v215, v220, v215
  v_pk_mul_f32 v[220:221], v[206:207], v[206:207] op_sel:[0,0] op_sel_hi:[1,0]
  v_pk_fma_f32 v[208:209], v[206:207], v[206:207], v[220:221] op_sel:[1,1,0] op_sel_hi:[0,1,1] neg_lo:[0,1,0]
  v_pk_mul_f32 v[220:221], v[208:209], v[208:209] op_sel:[0,0] op_sel_hi:[1,0]
  v_pk_fma_f32 v[210:211], v[208:209], v[208:209], v[220:221] op_sel:[1,1,0] op_sel_hi:[0,1,1] neg_lo:[0,1,0]
  v_cvt_pk_bf16_f32 v222, v204, -v205
  ds_write_b32 v198, v222 offset:0
  v_pk_mul_f32 v[220:221], v[204:205], v[206:207] op_sel:[0,0] op_sel_hi:[1,0]
  v_pk_fma_f32 v[216:217], v[204:205], v[206:207], v[220:221] op_sel:[1,1,0] op_sel_hi:[0,1,1] neg_lo:[0,1,0]
  v_cvt_pk_bf16_f32 v223, v216, -v217
  ds_write_b32 v198, v223 offset:544
  v_pk_mul_f32 v[220:221], v[216:217], v[206:207] op_sel:[0,0] op_sel_hi:[1,0]
  v_pk_fma_f32 v[218:219], v[216:217], v[206:207], v[220:221] op_sel:[1,1,0] op_sel_hi:[0,1,1] neg_lo:[0,1,0]
  v_cvt_pk_bf16_f32 v224, v218, -v219
  ds_write_b32 v198, v224 offset:1088
  v_pk_mul_f32 v[220:221], v[218:219], v[206:207] op_sel:[0,0] op_sel_hi:[1,0]
  buffer_load_dwordx4 a[100:103], v28, s[24:27], s50 offen offset:1024 sc1
  v_pk_fma_f32 v[216:217], v[218:219], v[206:207], v[220:221] op_sel:[1,1,0] op_sel_hi:[0,1,1] neg_lo:[0,1,0]
  v_cvt_pk_bf16_f32 v225, v216, -v217
  ds_write_b32 v198, v225 offset:1632
  v_pk_mul_f32 v[220:221], v[216:217], v[206:207] op_sel:[0,0] op_sel_hi:[1,0]
  v_pk_fma_f32 v[218:219], v[216:217], v[206:207], v[220:221] op_sel:[1,1,0] op_sel_hi:[0,1,1] neg_lo:[0,1,0]
  v_cvt_pk_bf16_f32 v222, v218, -v219
  ds_write_b32 v198, v222 offset:2176
  v_pk_mul_f32 v[220:221], v[218:219], v[206:207] op_sel:[0,0] op_sel_hi:[1,0]
  v_pk_fma_f32 v[216:217], v[218:219], v[206:207], v[220:221] op_sel:[1,1,0] op_sel_hi:[0,1,1] neg_lo:[0,1,0]
  v_cvt_pk_bf16_f32 v223, v216, -v217
  ds_write_b32 v198, v223 offset:2720
  v_pk_mul_f32 v[220:221], v[216:217], v[206:207] op_sel:[0,0] op_sel_hi:[1,0]
  v_pk_fma_f32 v[218:219], v[216:217], v[206:207], v[220:221] op_sel:[1,1,0] op_sel_hi:[0,1,1] neg_lo:[0,1,0]
  v_cvt_pk_bf16_f32 v224, v218, -v219
  ds_write_b32 v198, v224 offset:3264
  v_pk_mul_f32 v[220:221], v[218:219], v[206:207] op_sel:[0,0] op_sel_hi:[1,0]
  v_pk_fma_f32 v[216:217], v[218:219], v[206:207], v[220:221] op_sel:[1,1,0] op_sel_hi:[0,1,1] neg_lo:[0,1,0]
  v_cvt_pk_bf16_f32 v225, v216, -v217
  ds_write_b32 v198, v225 offset:3808
  v_pk_mul_f32 v[220:221], v[204:205], v[214:215] op_sel:[0,0] op_sel_hi:[1,0]
  buffer_load_dwordx4 a[104:107], v28, s[24:27], s50 offen offset:2048 sc1
  v_pk_fma_f32 v[226:227], v[204:205], v[214:215], v[220:221] op_sel:[1,1,0] op_sel_hi:[0,1,1] neg_lo:[0,1,0]
  v_cvt_pk_bf16_f32 v222, v226, -v227
  ds_write_b32 v198, v222 offset:4352
  v_pk_mul_f32 v[220:221], v[226:227], v[208:209] op_sel:[0,0] op_sel_hi:[1,0]
  v_pk_fma_f32 v[216:217], v[226:227], v[208:209], v[220:221] op_sel:[1,1,0] op_sel_hi:[0,1,1] neg_lo:[0,1,0]
  v_cvt_pk_bf16_f32 v223, v216, -v217
  ds_write_b32 v198, v223 offset:4896
  v_pk_mul_f32 v[220:221], v[216:217], v[208:209] op_sel:[0,0] op_sel_hi:[1,0]
  v_pk_fma_f32 v[218:219], v[216:217], v[208:209], v[220:221] op_sel:[1,1,0] op_sel_hi:[0,1,1] neg_lo:[0,1,0]
  v_cvt_pk_bf16_f32 v224, v218, -v219
  ds_write_b32 v198, v224 offset:5440
  v_pk_mul_f32 v[220:221], v[218:219], v[208:209] op_sel:[0,0] op_sel_hi:[1,0]
  v_pk_fma_f32 v[216:217], v[218:219], v[208:209], v[220:221] op_sel:[1,1,0] op_sel_hi:[0,1,1] neg_lo:[0,1,0]
  v_cvt_pk_bf16_f32 v225, v216, -v217
  ds_write_b32 v198, v225 offset:5984
  v_pk_mul_f32 v[220:221], v[226:227], v[214:215] op_sel:[0,0] op_sel_hi:[1,0]
  v_pk_fma_f32 v[228:229], v[226:227], v[214:215], v[220:221] op_sel:[1,1,0] op_sel_hi:[0,1,1] neg_lo:[0,1,0]
  v_cvt_pk_bf16_f32 v222, v228, -v229
  ds_write_b32 v198, v222 offset:6528
  v_pk_mul_f32 v[220:221], v[228:229], v[210:211] op_sel:[0,0] op_sel_hi:[1,0]
  buffer_load_dwordx4 a[108:111], v28, s[24:27], s50 offen offset:3072 sc1
  v_pk_fma_f32 v[216:217], v[228:229], v[210:211], v[220:221] op_sel:[1,1,0] op_sel_hi:[0,1,1] neg_lo:[0,1,0]
  v_cvt_pk_bf16_f32 v223, v216, -v217
  ds_write_b32 v198, v223 offset:7072
  v_pk_mul_f32 v[220:221], v[228:229], v[214:215] op_sel:[0,0] op_sel_hi:[1,0]
  v_pk_fma_f32 v[226:227], v[228:229], v[214:215], v[220:221] op_sel:[1,1,0] op_sel_hi:[0,1,1] neg_lo:[0,1,0]
  v_cvt_pk_bf16_f32 v224, v226, -v227
  ds_write_b32 v198, v224 offset:7616
  v_pk_mul_f32 v[220:221], v[226:227], v[210:211] op_sel:[0,0] op_sel_hi:[1,0]
  v_pk_fma_f32 v[216:217], v[226:227], v[210:211], v[220:221] op_sel:[1,1,0] op_sel_hi:[0,1,1] neg_lo:[0,1,0]
  v_cvt_pk_bf16_f32 v225, v216, -v217
  ds_write_b32 v198, v225 offset:8160
  v_pk_mul_f32 v[220:221], v[226:227], v[214:215] op_sel:[0,0] op_sel_hi:[1,0]
  v_pk_fma_f32 v[228:229], v[226:227], v[214:215], v[220:221] op_sel:[1,1,0] op_sel_hi:[0,1,1] neg_lo:[0,1,0]
  v_cvt_pk_bf16_f32 v222, v228, -v229
  ds_write_b32 v198, v222 offset:8704
  v_pk_mul_f32 v[220:221], v[228:229], v[214:215] op_sel:[0,0] op_sel_hi:[1,0]
  v_pk_fma_f32 v[226:227], v[228:229], v[214:215], v[220:221] op_sel:[1,1,0] op_sel_hi:[0,1,1] neg_lo:[0,1,0]
  v_cvt_pk_bf16_f32 v223, v226, -v227
  ds_write_b32 v198, v223 offset:9248
  v_pk_mul_f32 v[220:221], v[226:227], v[214:215] op_sel:[0,0] op_sel_hi:[1,0]
  s_add_u32 s50, s97, 28672
  buffer_load_dwordx4 a[112:115], v28, s[24:27], s50 offen offset:0 sc1
  v_pk_fma_f32 v[228:229], v[226:227], v[214:215], v[220:221] op_sel:[1,1,0] op_sel_hi:[0,1,1] neg_lo:[0,1,0]
  v_cvt_pk_bf16_f32 v224, v228, -v229
  ds_write_b32 v198, v224 offset:9792
  v_pk_mul_f32 v[220:221], v[228:229], v[214:215] op_sel:[0,0] op_sel_hi:[1,0]
  v_pk_fma_f32 v[226:227], v[228:229], v[214:215], v[220:221] op_sel:[1,1,0] op_sel_hi:[0,1,1] neg_lo:[0,1,0]
  v_cvt_pk_bf16_f32 v225, v226, -v227
  ds_write_b32 v198, v225 offset:10336
  v_pk_mul_f32 v[220:221], v[226:227], v[214:215] op_sel:[0,0] op_sel_hi:[1,0]
  v_pk_fma_f32 v[228:229], v[226:227], v[214:215], v[220:221] op_sel:[1,1,0] op_sel_hi:[0,1,1] neg_lo:[0,1,0]
  v_cvt_pk_bf16_f32 v222, v228, -v229
  ds_write_b32 v198, v222 offset:10880
  v_mov_b32 v216, 1.0
  v_mov_b32 v217, 0
  v_cvt_pk_bf16_f32 v223, v216, v217
  ds_write_b32 v198, v223 offset:34816
  v_cvt_pk_bf16_f32 v224, v212, v213
  ds_write_b32 v198, v224 offset:35360
  v_pk_mul_f32 v[220:221], v[212:213], v[212:213] op_sel:[0,0] op_sel_hi:[1,0]
  v_pk_fma_f32 v[216:217], v[212:213], v[212:213], v[220:221] op_sel:[1,1,0] op_sel_hi:[0,1,1] neg_lo:[0,1,0]
  v_cvt_pk_bf16_f32 v225, v216, v217
  buffer_load_dwordx4 a[116:119], v28, s[24:27], s50 offen offset:1024 sc1
  ds_write_b32 v198, v225 offset:35904
  v_pk_mul_f32 v[220:221], v[216:217], v[212:213] op_sel:[0,0] op_sel_hi:[1,0]
  v_pk_fma_f32 v[218:219], v[216:217], v[212:213], v[220:221] op_sel:[1,1,0] op_sel_hi:[0,1,1] neg_lo:[0,1,0]
  v_cvt_pk_bf16_f32 v222, v218, v219
  ds_write_b32 v198, v222 offset:36448
  v_pk_mul_f32 v[220:221], v[218:219], v[212:213] op_sel:[0,0] op_sel_hi:[1,0]
  v_pk_fma_f32 v[216:217], v[218:219], v[212:213], v[220:221] op_sel:[1,1,0] op_sel_hi:[0,1,1] neg_lo:[0,1,0]
  v_cvt_pk_bf16_f32 v223, v216, v217
  ds_write_b32 v198, v223 offset:36992
  v_pk_mul_f32 v[220:221], v[216:217], v[212:213] op_sel:[0,0] op_sel_hi:[1,0]
  v_pk_fma_f32 v[218:219], v[216:217], v[212:213], v[220:221] op_sel:[1,1,0] op_sel_hi:[0,1,1] neg_lo:[0,1,0]
  v_cvt_pk_bf16_f32 v224, v218, v219
  ds_write_b32 v198, v224 offset:37536
  v_pk_mul_f32 v[220:221], v[218:219], v[212:213] op_sel:[0,0] op_sel_hi:[1,0]
  v_pk_fma_f32 v[216:217], v[218:219], v[212:213], v[220:221] op_sel:[1,1,0] op_sel_hi:[0,1,1] neg_lo:[0,1,0]
  v_cvt_pk_bf16_f32 v225, v216, v217
  ds_write_b32 v198, v225 offset:38080
  v_pk_mul_f32 v[220:221], v[216:217], v[212:213] op_sel:[0,0] op_sel_hi:[1,0]
  v_pk_fma_f32 v[218:219], v[216:217], v[212:213], v[220:221] op_sel:[1,1,0] op_sel_hi:[0,1,1] neg_lo:[0,1,0]
  v_cvt_pk_bf16_f32 v222, v218, v219
  buffer_load_dwordx4 a[120:123], v28, s[24:27], s50 offen offset:2048 sc1
  ds_write_b32 v198, v222 offset:38624
  s_waitcnt vmcnt(8)
  s_barrier
  s_lshl_b32 s3, s5, 4
  s_add_u32 s3, s3, s6
  s_lshl_b32 s3, s3, 5
  s_add_u32 s3, s3, 4096
  v_mov_b32 v240, s72
  v_mov_b32 v241, 0
  s_mov_b64 s[74:75], exec
  s_mov_b64 exec, 1
  buffer_store_dword v240, v241, s[24:27], s3 offen sc1
  s_mov_b64 exec, s[74:75]
  v_pk_mul_f32 v[220:221], v[218:219], v[212:213] op_sel:[0,0] op_sel_hi:[1,0]
  v_pk_fma_f32 v[216:217], v[218:219], v[212:213], v[220:221] op_sel:[1,1,0] op_sel_hi:[0,1,1] neg_lo:[0,1,0]
  v_cvt_pk_bf16_f32 v223, v216, v217
  ds_write_b32 v198, v223 offset:39168
  v_pk_mul_f32 v[220:221], v[216:217], v[212:213] op_sel:[0,0] op_sel_hi:[1,0]
  v_pk_fma_f32 v[218:219], v[216:217], v[212:213], v[220:221] op_sel:[1,1,0] op_sel_hi:[0,1,1] neg_lo:[0,1,0]
  v_cvt_pk_bf16_f32 v224, v218, v219
  ds_write_b32 v198, v224 offset:39712
  v_pk_mul_f32 v[220:221], v[218:219], v[212:213] op_sel:[0,0] op_sel_hi:[1,0]
  v_pk_fma_f32 v[216:217], v[218:219], v[212:213], v[220:221] op_sel:[1,1,0] op_sel_hi:[0,1,1] neg_lo:[0,1,0]
  v_cvt_pk_bf16_f32 v225, v216, v217
  ds_write_b32 v198, v225 offset:40256
  v_pk_mul_f32 v[220:221], v[216:217], v[212:213] op_sel:[0,0] op_sel_hi:[1,0]
  v_pk_fma_f32 v[218:219], v[216:217], v[212:213], v[220:221] op_sel:[1,1,0] op_sel_hi:[0,1,1] neg_lo:[0,1,0]
  v_cvt_pk_bf16_f32 v222, v218, v219
  ds_write_b32 v198, v222 offset:40800
  v_pk_mul_f32 v[220:221], v[218:219], v[212:213] op_sel:[0,0] op_sel_hi:[1,0]
  v_pk_fma_f32 v[216:217], v[218:219], v[212:213], v[220:221] op_sel:[1,1,0] op_sel_hi:[0,1,1] neg_lo:[0,1,0]
  v_cvt_pk_bf16_f32 v223, v216, v217
  buffer_load_dwordx4 a[124:127], v28, s[24:27], s50 offen offset:3072 sc1
  ds_write_b32 v198, v223 offset:41344
  v_pk_mul_f32 v[220:221], v[216:217], v[212:213] op_sel:[0,0] op_sel_hi:[1,0]
  v_pk_fma_f32 v[218:219], v[216:217], v[212:213], v[220:221] op_sel:[1,1,0] op_sel_hi:[0,1,1] neg_lo:[0,1,0]
  v_cvt_pk_bf16_f32 v224, v218, v219
  ds_write_b32 v198, v224 offset:41888
  v_pk_mul_f32 v[220:221], v[218:219], v[212:213] op_sel:[0,0] op_sel_hi:[1,0]
  v_pk_fma_f32 v[216:217], v[218:219], v[212:213], v[220:221] op_sel:[1,1,0] op_sel_hi:[0,1,1] neg_lo:[0,1,0]
  v_cvt_pk_bf16_f32 v225, v216, v217
  ds_write_b32 v198, v225 offset:42432
  v_pk_mul_f32 v[220:221], v[216:217], v[212:213] op_sel:[0,0] op_sel_hi:[1,0]
  v_pk_fma_f32 v[218:219], v[216:217], v[212:213], v[220:221] op_sel:[1,1,0] op_sel_hi:[0,1,1] neg_lo:[0,1,0]
  v_cvt_pk_bf16_f32 v222, v218, v219
  ds_write_b32 v198, v222 offset:42976
  v_pk_mul_f32 v[220:221], v[218:219], v[212:213] op_sel:[0,0] op_sel_hi:[1,0]
  v_pk_fma_f32 v[216:217], v[218:219], v[212:213], v[220:221] op_sel:[1,1,0] op_sel_hi:[0,1,1] neg_lo:[0,1,0]
  v_cvt_pk_bf16_f32 v223, v216, v217
  ds_write_b32 v198, v223 offset:43520
  v_pk_mul_f32 v[220:221], v[216:217], v[212:213] op_sel:[0,0] op_sel_hi:[1,0]
  v_pk_fma_f32 v[218:219], v[216:217], v[212:213], v[220:221] op_sel:[1,1,0] op_sel_hi:[0,1,1] neg_lo:[0,1,0]
  v_cvt_pk_bf16_f32 v224, v218, v219
  s_add_u32 s50, s97, 32768
  buffer_load_dwordx4 a[128:131], v28, s[24:27], s50 offen offset:0 sc1
  ds_write_b32 v198, v224 offset:44064
  v_pk_mul_f32 v[220:221], v[218:219], v[212:213] op_sel:[0,0] op_sel_hi:[1,0]
  v_pk_fma_f32 v[216:217], v[218:219], v[212:213], v[220:221] op_sel:[1,1,0] op_sel_hi:[0,1,1] neg_lo:[0,1,0]
  v_cvt_pk_bf16_f32 v225, v216, v217
  ds_write_b32 v198, v225 offset:44608
  v_pk_mul_f32 v[220:221], v[216:217], v[212:213] op_sel:[0,0] op_sel_hi:[1,0]
  v_pk_fma_f32 v[218:219], v[216:217], v[212:213], v[220:221] op_sel:[1,1,0] op_sel_hi:[0,1,1] neg_lo:[0,1,0]
  v_cvt_pk_bf16_f32 v222, v218, v219
  ds_write_b32 v198, v222 offset:45152
  v_pk_mul_f32 v[220:221], v[218:219], v[212:213] op_sel:[0,0] op_sel_hi:[1,0]
  v_pk_fma_f32 v[216:217], v[218:219], v[212:213], v[220:221] op_sel:[1,1,0] op_sel_hi:[0,1,1] neg_lo:[0,1,0]
  v_cvt_pk_bf16_f32 v223, v216, v217
  ds_write_b32 v198, v223 offset:45696
  v_pk_mul_f32 v[220:221], v[216:217], v[212:213] op_sel:[0,0] op_sel_hi:[1,0]
  v_pk_fma_f32 v[218:219], v[216:217], v[212:213], v[220:221] op_sel:[1,1,0] op_sel_hi:[0,1,1] neg_lo:[0,1,0]
  v_cvt_pk_bf16_f32 v224, v218, v219
  ds_write_b32 v198, v224 offset:46240
  v_pk_mul_f32 v[220:221], v[218:219], v[212:213] op_sel:[0,0] op_sel_hi:[1,0]
  v_pk_fma_f32 v[216:217], v[218:219], v[212:213], v[220:221] op_sel:[1,1,0] op_sel_hi:[0,1,1] neg_lo:[0,1,0]
  v_cvt_pk_bf16_f32 v225, v216, v217
  buffer_load_dwordx4 a[132:135], v28, s[24:27], s50 offen offset:1024 sc1
  ds_write_b32 v198, v225 offset:46784
  v_pk_mul_f32 v[220:221], v[216:217], v[212:213] op_sel:[0,0] op_sel_hi:[1,0]
  v_pk_fma_f32 v[218:219], v[216:217], v[212:213], v[220:221] op_sel:[1,1,0] op_sel_hi:[0,1,1] neg_lo:[0,1,0]
  v_cvt_pk_bf16_f32 v222, v218, v219
  ds_write_b32 v198, v222 offset:47328
  v_pk_mul_f32 v[220:221], v[218:219], v[212:213] op_sel:[0,0] op_sel_hi:[1,0]
  v_pk_fma_f32 v[216:217], v[218:219], v[212:213], v[220:221] op_sel:[1,1,0] op_sel_hi:[0,1,1] neg_lo:[0,1,0]
  v_cvt_pk_bf16_f32 v223, v216, v217
  ds_write_b32 v198, v223 offset:47872
  v_pk_mul_f32 v[220:221], v[216:217], v[212:213] op_sel:[0,0] op_sel_hi:[1,0]
  v_pk_fma_f32 v[218:219], v[216:217], v[212:213], v[220:221] op_sel:[1,1,0] op_sel_hi:[0,1,1] neg_lo:[0,1,0]
  v_cvt_pk_bf16_f32 v224, v218, v219
  ds_write_b32 v198, v224 offset:48416
  v_pk_mul_f32 v[220:221], v[218:219], v[212:213] op_sel:[0,0] op_sel_hi:[1,0]
  v_pk_fma_f32 v[216:217], v[218:219], v[212:213], v[220:221] op_sel:[1,1,0] op_sel_hi:[0,1,1] neg_lo:[0,1,0]
  v_cvt_pk_bf16_f32 v225, v216, v217
  ds_write_b32 v198, v225 offset:48960
  v_pk_mul_f32 v[220:221], v[216:217], v[212:213] op_sel:[0,0] op_sel_hi:[1,0]
  v_pk_fma_f32 v[218:219], v[216:217], v[212:213], v[220:221] op_sel:[1,1,0] op_sel_hi:[0,1,1] neg_lo:[0,1,0]
  v_cvt_pk_bf16_f32 v222, v218, v219
  buffer_load_dwordx4 a[136:139], v28, s[24:27], s50 offen offset:2048 sc1
  ds_write_b32 v198, v222 offset:49504
  v_pk_mul_f32 v[220:221], v[218:219], v[212:213] op_sel:[0,0] op_sel_hi:[1,0]
  v_pk_fma_f32 v[216:217], v[218:219], v[212:213], v[220:221] op_sel:[1,1,0] op_sel_hi:[0,1,1] neg_lo:[0,1,0]
  v_cvt_pk_bf16_f32 v223, v216, v217
  ds_write_b32 v198, v223 offset:50048
  v_pk_mul_f32 v[220:221], v[216:217], v[212:213] op_sel:[0,0] op_sel_hi:[1,0]
  v_pk_fma_f32 v[218:219], v[216:217], v[212:213], v[220:221] op_sel:[1,1,0] op_sel_hi:[0,1,1] neg_lo:[0,1,0]
  v_cvt_pk_bf16_f32 v224, v218, v219
  ds_write_b32 v198, v224 offset:50592
  v_pk_mul_f32 v[220:221], v[218:219], v[212:213] op_sel:[0,0] op_sel_hi:[1,0]
  v_pk_fma_f32 v[216:217], v[218:219], v[212:213], v[220:221] op_sel:[1,1,0] op_sel_hi:[0,1,1] neg_lo:[0,1,0]
  v_cvt_pk_bf16_f32 v225, v216, v217
  ds_write_b32 v198, v225 offset:51136
  v_pk_mul_f32 v[220:221], v[216:217], v[212:213] op_sel:[0,0] op_sel_hi:[1,0]
  v_pk_fma_f32 v[218:219], v[216:217], v[212:213], v[220:221] op_sel:[1,1,0] op_sel_hi:[0,1,1] neg_lo:[0,1,0]
  v_cvt_pk_bf16_f32 v222, v218, v219
  ds_write_b32 v198, v222 offset:51680
  s_lshr_b32 s3, s4, 1
  s_mul_i32 s3, s3, 17408
  v_mul_u32_u24 v44, 544, v2
  v_lshl_add_u32 v44, v3, 4, v44
  v_add_u32 v44, s3, v44
  s_and_b32 s10, s4, 1
  s_mul_i32 s10, s10, 8704
  s_add_u32 s10, s10, 34816
  v_add_u32 v45, s10, v44
  v_accvgpr_read_b32 v160, a240
  s_waitcnt lgkmcnt(0)
  s_barrier
  ds_read_b128 v[128:131], v45 offset:0
  buffer_load_dwordx4 a[140:143], v28, s[24:27], s50 offen offset:3072 sc1
  ds_read_b128 v[64:67], v44 offset:0
  ds_read_b128 v[68:71], v44 offset:8704
  ds_read_b128 v[132:135], v45 offset:64
  ds_read_b128 v[72:75], v44 offset:64
  ds_read_b128 v[76:79], v44 offset:8768
  ds_read_b128 v[136:139], v45 offset:128
  ds_read_b128 v[80:83], v44 offset:128
  ds_read_b128 v[84:87], v44 offset:8832
  ds_read_b128 v[140:143], v45 offset:192
  ds_read_b128 v[88:91], v44 offset:192
  s_add_u32 s50, s97, 36864
  buffer_load_dwordx4 a[144:147], v28, s[24:27], s50 offen offset:0 sc1
  ds_read_b128 v[92:95], v44 offset:8896
  s_waitcnt lgkmcnt(9)
  v_mfma_f32_16x16x32_bf16 v[36:39], v[64:67], v[128:131], 0
  v_mfma_f32_16x16x32_bf16 v[40:43], v[68:71], v[128:131], 0
  ds_read_b128 v[144:147], v45 offset:256
  ds_read_b128 v[96:99], v44 offset:256
  ds_read_b128 v[100:103], v44 offset:8960
  s_waitcnt lgkmcnt(9)
  v_mfma_f32_16x16x32_bf16 v[36:39], v[72:75], v[132:135], v[36:39]
  v_mfma_f32_16x16x32_bf16 v[40:43], v[76:79], v[132:135], v[40:43]
  ds_read_b128 v[148:151], v45 offset:320
  ds_read_b128 v[104:107], v44 offset:320
  buffer_load_dwordx4 a[148:151], v28, s[24:27], s50 offen offset:1024 sc1
  ds_read_b128 v[108:111], v44 offset:9024
  s_waitcnt lgkmcnt(9)
  v_mfma_f32_16x16x32_bf16 v[36:39], v[80:83], v[136:139], v[36:39]
  v_mfma_f32_16x16x32_bf16 v[40:43], v[84:87], v[136:139], v[40:43]
  ds_read_b128 v[152:155], v45 offset:384
  ds_read_b128 v[112:115], v44 offset:384
  ds_read_b128 v[116:119], v44 offset:9088
  s_waitcnt lgkmcnt(9)
  v_mfma_f32_16x16x32_bf16 v[36:39], v[88:91], v[140:143], v[36:39]
  v_mfma_f32_16x16x32_bf16 v[40:43], v[92:95], v[140:143], v[40:43]
  ds_read_b128 v[156:159], v45 offset:448
  ds_read_b128 v[120:123], v44 offset:448
  buffer_load_dwordx4 a[152:155], v28, s[24:27], s50 offen offset:2048 sc1
  ds_read_b128 v[124:127], v44 offset:9152
  s_waitcnt lgkmcnt(9)
  v_mfma_f32_16x16x32_bf16 v[36:39], v[96:99], v[144:147], v[36:39]
  v_mfma_f32_16x16x32_bf16 v[40:43], v[100:103], v[144:147], v[40:43]
  v_accvgpr_read_b32 v49, a235
  v_accvgpr_read_b32 v50, a236
  v_accvgpr_read_b32 v51, a237
  v_mov_b32 v60, 0
  v_mov_b32 v61, 0
  v_mov_b32 v62, 0
  v_mov_b32 v63, 0
  buffer_load_dwordx4 a[156:159], v28, s[24:27], s50 offen offset:3072 sc1
  s_lshr_b32 s3, s4, 1
  s_mul_i32 s3, s3, 17408
  s_add_u32 s3, s3, 13056
  v_mov_b32 v52, s3
  ds_write_b16 v52, v60 offset:2000
  s_waitcnt lgkmcnt(7)
  v_mfma_f32_16x16x32_bf16 v[36:39], v[104:107], v[148:151], v[36:39]
  v_mfma_f32_16x16x32_bf16 v[40:43], v[108:111], v[148:151], v[40:43]
  s_waitcnt lgkmcnt(4)
  v_mfma_f32_16x16x32_bf16 v[36:39], v[112:115], v[152:155], v[36:39]
  v_mfma_f32_16x16x32_bf16 v[40:43], v[116:119], v[152:155], v[40:43]
  s_waitcnt lgkmcnt(1)
  v_mfma_f32_16x16x32_bf16 v[36:39], v[120:123], v[156:159], v[36:39]
  s_add_u32 s50, s97, 40960
  buffer_load_dwordx4 a[160:163], v28, s[24:27], s50 offen offset:0 sc1
  v_mfma_f32_16x16x32_bf16 v[40:43], v[124:127], v[156:159], v[40:43]
  v_and_b32 v52, 15, v1
  v_lshrrev_b32 v48, 1, v52
  v_mul_u32_u24 v48, 4160, v48
  v_and_b32 v52, 1, v52
  v_lshl_add_u32 v48, v52, 4, v48
  v_add_u32 v48, 77824, v48
  ds_write_b128 v48, v[60:63]
  v_lshrrev_b32 v48, 5, v1
  v_mul_u32_u24 v48, 4608, v48
  buffer_load_dwordx4 a[164:167], v28, s[24:27], s50 offen offset:1024 sc1
  v_and_b32 v52, 31, v1
  v_lshl_add_u32 v48, v52, 4, v48
  v_add_u32 v48, 107008, v48
  ds_write_b128 v48, v[60:63]
  v_cvt_pk_bf16_f32 v54, v36, v37
  v_cvt_pk_bf16_f32 v55, v38, v39
  v_cvt_pk_bf16_f32 v56, v40, v41
  v_cvt_pk_bf16_f32 v57, v42, v43
  ds_write_b32 v49, v54
  ds_write_b32 v50, v55
  buffer_load_dwordx4 a[168:171], v28, s[24:27], s50 offen offset:2048 sc1
  ds_write_b16 v51, v56
  ds_write_b16_d16_hi v51, v56 offset:64
  ds_write_b16 v51, v57 offset:128
  ds_write_b16_d16_hi v51, v57 offset:192
  v_accvgpr_read_b32 v76, a224
  v_accvgpr_read_b32 v77, a225
  v_accvgpr_read_b32 v78, a226
  v_accvgpr_read_b32 v79, a227
  v_accvgpr_read_b32 v80, a228
  v_accvgpr_read_b32 v81, a229
  buffer_load_dwordx4 a[172:175], v28, s[24:27], s50 offen offset:3072 sc1
  v_and_b32 v64, 0xffff, v76
  v_lshrrev_b32 v65, 16, v76
  v_and_b32 v66, 0xffff, v77
  v_lshrrev_b32 v67, 16, v77
  v_and_b32 v68, 0xffff, v78
  v_lshrrev_b32 v69, 16, v78
  v_and_b32 v70, 0xffff, v79
  v_lshrrev_b32 v71, 16, v79
  v_and_b32 v72, 0xffff, v80
  v_lshrrev_b32 v73, 16, v80
  s_add_u32 s50, s97, 45056
  buffer_load_dwordx4 a[176:179], v28, s[24:27], s50 offen offset:0 sc1
  v_and_b32 v74, 0xffff, v81
  v_accvgpr_read_b32 v24, a238
  v_accvgpr_read_b32 v25, a239
  s_waitcnt lgkmcnt(0)
  s_barrier
  s_mov_b32 s89, 0xffff0000
  v_lshlrev_b32 v128, 4, v0
  v_add_u32 v128, 73728, v128
  ds_read_u16 v80, v64 offset:13056
  ds_read_u16_d16_hi v112, v65 offset:13056
  ds_read_u16 v81, v66 offset:13056
  ds_read_u16_d16_hi v113, v67 offset:13056
  ds_read_u16 v82, v68 offset:13056
  ds_read_u16_d16_hi v114, v69 offset:13056
  ds_read_u16 v83, v70 offset:13056
  ds_read_u16_d16_hi v115, v71 offset:13056
  ds_read_u16 v84, v72 offset:13056
  ds_read_u16_d16_hi v116, v73 offset:13056
  ds_read_u16 v85, v74 offset:13056
  ds_read_u16 v88, v64 offset:30464
  ds_read_u16_d16_hi v120, v65 offset:30464
  ds_read_u16 v89, v66 offset:30464
  ds_read_u16_d16_hi v121, v67 offset:30464
  ds_read_u16 v90, v68 offset:30464
  ds_read_u16_d16_hi v122, v69 offset:30464
  ds_read_u16 v91, v70 offset:30464
  ds_read_u16_d16_hi v123, v71 offset:30464
  ds_read_u16 v92, v72 offset:30464
  ds_read_u16_d16_hi v124, v73 offset:30464
  ds_read_u16 v93, v74 offset:30464
  s_add_u32 s3, s4, 1
  s_and_b32 s3, s3, 3
  s_lshl_b32 s10, s8, 2
  s_add_u32 s3, s3, s10
  s_lshl_b32 s3, s3, 3
  s_lshl_b32 s10, s4, 1
  s_add_u32 s3, s3, s10
  s_mul_i32 s3, s3, 7168
  s_add_u32 s32, s3, 4325376
  s_add_u32 s3, s4, 2
  s_and_b32 s3, s3, 3
  s_lshl_b32 s10, s8, 2
  s_add_u32 s3, s3, s10
  s_lshl_b32 s3, s3, 3
  s_lshl_b32 s10, s4, 1
  s_add_u32 s3, s3, s10
  s_mul_i32 s3, s3, 7168
  s_add_u32 s33, s3, 4325376
  s_add_u32 s3, s4, 3
  s_and_b32 s3, s3, 3
  s_lshl_b32 s10, s8, 2
  s_add_u32 s3, s3, s10
  s_lshl_b32 s3, s3, 3
  s_lshl_b32 s10, s4, 1
  s_add_u32 s3, s3, s10
  s_mul_i32 s3, s3, 7168
  s_add_u32 s34, s3, 4325376
  s_add_u32 s3, s4, 4
  s_and_b32 s3, s3, 3
  s_lshl_b32 s10, s8, 2
  s_add_u32 s3, s3, s10
  s_lshl_b32 s3, s3, 3
  s_lshl_b32 s10, s4, 1
  s_add_u32 s3, s3, s10
  s_mul_i32 s3, s3, 7168
  s_add_u32 s35, s3, 4325376
  buffer_load_dword v161, v160, s[24:27], 0 offen sc1
  s_waitcnt lgkmcnt(11)
  v_and_or_b32 v80, v112, s89, v80
  buffer_load_dwordx4 a[180:183], v28, s[24:27], s50 offen offset:1024 sc1
  v_and_or_b32 v81, v113, s89, v81
  v_and_or_b32 v82, v114, s89, v82
  v_and_or_b32 v83, v115, s89, v83
  v_and_or_b32 v84, v116, s89, v84
  v_alignbit_b32 v96, v81, v80, 16
  v_alignbit_b32 v97, v82, v81, 16
  v_alignbit_b32 v98, v83, v82, 16
  v_alignbit_b32 v99, v84, v83, 16
  v_alignbit_b32 v100, v85, v84, 16
  buffer_load_dwordx4 a[184:187], v28, s[24:27], s50 offen offset:2048 sc1
  ds_write_b128 v128, v[80:83] offset:0
  ds_write_b128 v128, v[96:99] offset:4160
  v_add_u32 v129, 8320, v128
  ds_write2_b32 v129, v81, v82 offset0:0 offset1:1
  ds_write2_b32 v129, v83, v84 offset0:2 offset1:3
  v_add_u32 v130, 12480, v128
  ds_write2_b32 v130, v97, v98 offset0:0 offset1:1
  ds_write2_b32 v130, v99, v100 offset0:2 offset1:3
  s_waitcnt lgkmcnt(6)
  v_and_or_b32 v88, v120, s89, v88
  buffer_load_dwordx4 a[188:191], v28, s[24:27], s50 offen offset:3072 sc1
  v_and_or_b32 v89, v121, s89, v89
  v_and_or_b32 v90, v122, s89, v90
  v_and_or_b32 v91, v123, s89, v91
  v_and_or_b32 v92, v124, s89, v92
  v_alignbit_b32 v104, v89, v88, 16
  v_alignbit_b32 v105, v90, v89, 16
  v_alignbit_b32 v106, v91, v90, 16
  v_alignbit_b32 v107, v92, v91, 16
  v_alignbit_b32 v108, v93, v92, 16
  s_add_u32 s50, s97, 49152
  buffer_load_dwordx4 a[192:195], v28, s[24:27], s50 offen offset:0 sc1
  ds_write_b128 v128, v[88:91] offset:16640
  ds_write_b128 v128, v[104:107] offset:20800
  v_add_u32 v129, 24960, v128
  ds_write2_b32 v129, v89, v90 offset0:0 offset1:1
  ds_write2_b32 v129, v91, v92 offset0:2 offset1:3
  v_add_u32 v130, 29120, v128
  ds_write2_b32 v130, v105, v106 offset0:0 offset1:1
  ds_write2_b32 v130, v107, v108 offset0:2 offset1:3
  buffer_load_dwordx4 a[196:199], v28, s[24:27], s50 offen offset:1024 sc1
  buffer_load_dwordx4 a[200:203], v28, s[24:27], s50 offen offset:2048 sc1
  buffer_load_dwordx4 a[204:207], v28, s[24:27], s50 offen offset:3072 sc1
  s_add_u32 s50, s97, 53248
  buffer_load_dwordx4 a[208:211], v28, s[24:27], s50 offen offset:0 sc1
  buffer_load_dwordx4 a[212:215], v28, s[24:27], s50 offen offset:1024 sc1
  buffer_load_dwordx4 a[216:219], v28, s[24:27], s50 offen offset:2048 sc1
  buffer_load_dwordx4 a[220:223], v28, s[24:27], s50 offen offset:3072 sc1
  s_cmp_lg_u32 s4, 0
  s_cbranch_scc1 L_ok_U
  s_waitcnt vmcnt(11)
  v_cmp_ne_u32 vcc, s72, v161
  s_nop 0
  s_cmp_eq_u64 vcc, 0
  s_cbranch_scc1 L_ok_U
  s_mov_b32 s92, 400000
L_poll_U:
  s_sleep 2
  buffer_load_dword v161, v160, s[24:27], 0 offen sc1
  s_waitcnt vmcnt(0)
  v_cmp_ne_u32 vcc, s72, v161
  s_sub_u32 s92, s92, 1
  s_cmp_eq_u32 s92, 0
  s_cbranch_scc1 L_ok_U
  s_cmp_lg_u64 vcc, 0
  s_cbranch_scc1 L_poll_U
L_ok_U:
  s_waitcnt lgkmcnt(0)
  s_barrier
  s_lshl_b32 s3, s2, 13
  s_lshl_b32 s10, s4, 11
  s_add_u32 s3, s3, s10
  s_add_u32 s3, s3, 131072
  v_lshlrev_b32 v160, 4, v1
  buffer_load_dwordx4 v[164:167], v160, s[24:27], s3 offen sc1
  buffer_load_dwordx4 v[168:171], v160, s[24:27], s3 offen offset:1024 sc1
  s_lshl_b32 s3, s8, 8
  s_lshl_b32 s10, s4, 6
  s_add_u32 s3, s3, s10
  s_add_u32 s3, s3, 114688
  v_lshlrev_b32 v31, 2, v2
  buffer_load_dword v31, v31, s[24:27], s3 offen sc1
  s_lshr_b32 s3, s4, 1
  s_mul_i32 s3, s3, 4608
  s_and_b32 s10, s4, 1
  s_lshl_b32 s10, s10, 11
  s_add_u32 s3, s3, s10
  s_add_u32 s3, s3, 107520
  v_add_u32 v160, s3, v160
  v_lshlrev_b32 v30, 4, v1
  v_lshlrev_b32 v0, 3, v1
  s_add_u32 s50, s33, 0
  buffer_load_dwordx4 v[184:187], v30, s[24:27], s50 offen offset:0 sc1
  buffer_load_dwordx4 v[188:191], v30, s[24:27], s50 offen offset:1024 sc1
  buffer_load_dwordx4 v[192:195], v30, s[24:27], s50 offen offset:2048 sc1
  buffer_load_dwordx4 v[196:199], v30, s[24:27], s50 offen offset:3072 sc1
  s_add_u32 s50, s33, 4096
  buffer_load_dwordx4 v[200:203], v30, s[24:27], s50 offen offset:0 sc1
  buffer_load_dwordx4 v[204:207], v30, s[24:27], s50 offen offset:1024 sc1
  buffer_load_dwordx2 v[208:209], v0, s[24:27], s50 offen offset:2048 sc1
  buffer_load_dwordx2 v[210:211], v0, s[24:27], s50 offen offset:2560 sc1
  buffer_load_dwordx4 v[212:215], v30, s[24:27], s50 offen offset:3072 sc1
  ds_read_b64 v[64:65], v24 offset:3776
  ds_read_b64 v[66:67], v24 offset:3784
  ds_read_b64 v[68:69], v24 offset:3264
  ds_read_b64 v[70:71], v24 offset:3272
  ds_read_b64 v[72:73], v24 offset:2752
  ds_read_b64 v[74:75], v24 offset:2760
  ds_read_b64 v[76:77], v24 offset:2240
  ds_read_b64 v[78:79], v24 offset:2248
  ds_read_b64 v[80:81], v24 offset:1728
  ds_read_b64 v[82:83], v24 offset:1736
  ds_read_b64 v[84:85], v24 offset:1216
  ds_read_b64 v[86:87], v24 offset:1224
  ds_read_b64 v[88:89], v24 offset:704
  ds_read_b64 v[90:91], v24 offset:712
  ds_read_b64 v[92:93], v24 offset:192
  ds_read_b64 v[94:95], v24 offset:200
  s_waitcnt vmcnt(10)
  ds_write_b128 v160, v[164:167]
  ds_write_b128 v160, v[168:171] offset:1024
  s_waitcnt lgkmcnt(0)
  s_barrier
  s_lshl_b32 s3, s4, 13
  s_add_u32 s3, s3, 116224
  v_lshl_add_u32 v26, v2, 2, v3
  v_lshl_add_u32 v26, v26, 4, s3
  ds_read_b128 v[4:7], v25 offset:192
  ds_read_b128 v[8:11], v25 offset:704
  ds_read_b128 v[12:15], v25 offset:1216
  ds_read_b128 v[16:19], v25 offset:1728
  ds_read_b128 v[20:23], v25 offset:2240
  ds_read_b128 v[240:243], v25 offset:2752
  ds_read_b128 v[244:247], v25 offset:3264
  ds_read_b128 v[248:251], v25 offset:3776
  s_waitcnt lgkmcnt(2)
  v_mfma_f32_16x16x32_bf16 v[32:35], v[64:67], v[4:7], 0
  ds_read_b64 v[96:97], v24 offset:3712
  v_mfma_f32_16x16x32_bf16 v[36:39], v[64:67], v[8:11], 0
  s_add_u32 s50, s32, 0
  ds_read_b64 v[98:99], v24 offset:3720
  v_mfma_f32_16x16x32_bf16 v[36:39], v[68:71], v[4:7], v[36:39]
  buffer_load_dwordx4 v[128:131], v30, s[24:27], s50 offen offset:0 sc1
  v_mfma_f32_16x16x32_bf16 v[40:43], v[64:67], v[12:15], 0
  ds_read_b128 a[224:227], v25 offset:128
  v_mfma_f32_16x16x32_bf16 v[40:43], v[68:71], v[8:11], v[40:43]
  ds_read_b64 v[100:101], v24 offset:3200
  v_mfma_f32_16x16x32_bf16 v[40:43], v[72:75], v[4:7], v[40:43]
  v_mfma_f32_16x16x32_bf16 v[44:47], v[64:67], v[16:19], 0
  ds_read_b64 v[102:103], v24 offset:3208
  v_mfma_f32_16x16x32_bf16 v[44:47], v[68:71], v[12:15], v[44:47]
  ds_read_b128 a[228:231], v25 offset:640
  v_mfma_f32_16x16x32_bf16 v[44:47], v[72:75], v[8:11], v[44:47]
  buffer_load_dwordx4 v[132:135], v30, s[24:27], s50 offen offset:1024 sc1
  v_mfma_f32_16x16x32_bf16 v[44:47], v[76:79], v[4:7], v[44:47]
  ds_read_b64 v[104:105], v24 offset:2688
  v_mfma_f32_16x16x32_bf16 v[48:51], v[64:67], v[20:23], 0
  ds_read_b64 v[106:107], v24 offset:2696
  v_mfma_f32_16x16x32_bf16 v[48:51], v[68:71], v[16:19], v[48:51]
  v_mfma_f32_16x16x32_bf16 v[48:51], v[72:75], v[12:15], v[48:51]
  ds_read_b128 a[232:235], v25 offset:1152
  v_mfma_f32_16x16x32_bf16 v[48:51], v[76:79], v[8:11], v[48:51]
  ds_read_b64 v[108:109], v24 offset:2176
  v_mfma_f32_16x16x32_bf16 v[48:51], v[80:83], v[4:7], v[48:51]
  buffer_load_dwordx4 v[136:139], v30, s[24:27], s50 offen offset:2048 sc1
  v_mfma_f32_16x16x32_bf16 v[52:55], v[64:67], v[240:243], 0
  ds_read_b64 v[110:111], v24 offset:2184
  v_mfma_f32_16x16x32_bf16 v[52:55], v[68:71], v[20:23], v[52:55]
  ds_read_b128 a[236:239], v25 offset:1664
  v_mfma_f32_16x16x32_bf16 v[52:55], v[72:75], v[16:19], v[52:55]
  v_mfma_f32_16x16x32_bf16 v[52:55], v[76:79], v[12:15], v[52:55]
  ds_read_b64 v[112:113], v24 offset:1664
  v_mfma_f32_16x16x32_bf16 v[52:55], v[80:83], v[8:11], v[52:55]
  ds_read_b64 v[114:115], v24 offset:1672
  v_mfma_f32_16x16x32_bf16 v[52:55], v[84:87], v[4:7], v[52:55]
  s_waitcnt lgkmcnt(14)
  v_mfma_f32_16x16x32_bf16 v[56:59], v[64:67], v[244:247], 0
  ds_read_b128 a[240:243], v25 offset:2176
  v_mfma_f32_16x16x32_bf16 v[56:59], v[68:71], v[240:243], v[56:59]
  ds_read_b64 v[116:117], v24 offset:1152
  v_mfma_f32_16x16x32_bf16 v[56:59], v[72:75], v[20:23], v[56:59]
  buffer_load_dwordx4 v[140:143], v30, s[24:27], s50 offen offset:3072 sc1
  v_mfma_f32_16x16x32_bf16 v[56:59], v[76:79], v[16:19], v[56:59]
  ds_read_b64 v[118:119], v24 offset:1160
  v_mfma_f32_16x16x32_bf16 v[56:59], v[80:83], v[12:15], v[56:59]
  ds_read_b128 a[244:247], v25 offset:2688
  v_mfma_f32_16x16x32_bf16 v[56:59], v[84:87], v[8:11], v[56:59]
  v_mfma_f32_16x16x32_bf16 v[56:59], v[88:91], v[4:7], v[56:59]
  ds_read_b64 v[120:121], v24 offset:640
  v_mfma_f32_16x16x32_bf16 v[60:63], v[64:67], v[248:251], 0
  s_add_u32 s50, s32, 4096
  ds_read_b64 v[122:123], v24 offset:648
  v_mfma_f32_16x16x32_bf16 v[60:63], v[68:71], v[244:247], v[60:63]
  buffer_load_dwordx4 v[144:147], v30, s[24:27], s50 offen offset:0 sc1
  v_mfma_f32_16x16x32_bf16 v[60:63], v[72:75], v[240:243], v[60:63]
  ds_read_b128 a[248:251], v25 offset:3200
  v_mfma_f32_16x16x32_bf16 v[60:63], v[76:79], v[20:23], v[60:63]
  ds_read_b64 v[124:125], v24 offset:128
  v_mfma_f32_16x16x32_bf16 v[60:63], v[80:83], v[16:19], v[60:63]
  v_mfma_f32_16x16x32_bf16 v[60:63], v[84:87], v[12:15], v[60:63]
  ds_read_b64 v[126:127], v24 offset:136
  v_mfma_f32_16x16x32_bf16 v[60:63], v[88:91], v[8:11], v[60:63]
  ds_read_b128 a[252:255], v25 offset:3712
  v_mfma_f32_16x16x32_bf16 v[60:63], v[92:95], v[4:7], v[60:63]
  s_waitcnt lgkmcnt(6)
  v_mfma_f32_16x16x32_bf16 v[32:35], v[96:99], a[224:227], v[32:35]
  ds_read_b64 v[64:65], v24 offset:3648
  v_mfma_f32_16x16x32_bf16 v[36:39], v[96:99], a[228:231], v[36:39]
  ds_read_b64 v[66:67], v24 offset:3656
  v_mfma_f32_16x16x32_bf16 v[36:39], v[100:103], a[224:227], v[36:39]
  buffer_load_dwordx4 v[148:151], v30, s[24:27], s50 offen offset:1024 sc1
  v_mfma_f32_16x16x32_bf16 v[40:43], v[96:99], a[232:235], v[40:43]
  ds_read_b128 v[4:7], v25 offset:64
  v_mfma_f32_16x16x32_bf16 v[40:43], v[100:103], a[228:231], v[40:43]
  ds_read_b64 v[68:69], v24 offset:3136
  v_mfma_f32_16x16x32_bf16 v[40:43], v[104:107], a[224:227], v[40:43]
  v_mfma_f32_16x16x32_bf16 v[44:47], v[96:99], a[236:239], v[44:47]
  ds_read_b64 v[70:71], v24 offset:3144
  v_mfma_f32_16x16x32_bf16 v[44:47], v[100:103], a[232:235], v[44:47]
  ds_read_b128 v[8:11], v25 offset:576
  v_mfma_f32_16x16x32_bf16 v[44:47], v[104:107], a[228:231], v[44:47]
  buffer_load_dwordx2 v[152:153], v0, s[24:27], s50 offen offset:2048 sc1
  buffer_load_dwordx2 v[154:155], v0, s[24:27], s50 offen offset:2560 sc1
  v_mfma_f32_16x16x32_bf16 v[44:47], v[108:111], a[224:227], v[44:47]
  ds_read_b64 v[72:73], v24 offset:2624
  v_mfma_f32_16x16x32_bf16 v[48:51], v[96:99], a[240:243], v[48:51]
  ds_read_b64 v[74:75], v24 offset:2632
  v_mfma_f32_16x16x32_bf16 v[48:51], v[100:103], a[236:239], v[48:51]
  v_mfma_f32_16x16x32_bf16 v[48:51], v[104:107], a[232:235], v[48:51]
  ds_read_b128 v[12:15], v25 offset:1088
  v_mfma_f32_16x16x32_bf16 v[48:51], v[108:111], a[228:231], v[48:51]
  ds_read_b64 v[76:77], v24 offset:2112
  v_mfma_f32_16x16x32_bf16 v[48:51], v[112:115], a[224:227], v[48:51]
  buffer_load_dwordx4 v[156:159], v30, s[24:27], s50 offen offset:3072 sc1
  v_mfma_f32_16x16x32_bf16 v[52:55], v[96:99], a[244:247], v[52:55]
  ds_read_b64 v[78:79], v24 offset:2120
  v_mfma_f32_16x16x32_bf16 v[52:55], v[100:103], a[240:243], v[52:55]
  ds_read_b128 v[16:19], v25 offset:1600
  v_mfma_f32_16x16x32_bf16 v[52:55], v[104:107], a[236:239], v[52:55]
  v_mfma_f32_16x16x32_bf16 v[52:55], v[108:111], a[232:235], v[52:55]
  ds_read_b64 v[80:81], v24 offset:1600
  v_mfma_f32_16x16x32_bf16 v[52:55], v[112:115], a[228:231], v[52:55]
  ds_read_b64 v[82:83], v24 offset:1608
  v_mfma_f32_16x16x32_bf16 v[52:55], v[116:119], a[224:227], v[52:55]
  s_waitcnt lgkmcnt(14)
  v_mfma_f32_16x16x32_bf16 v[56:59], v[96:99], a[248:251], v[56:59]
  ds_read_b128 v[20:23], v25 offset:2112
  v_mfma_f32_16x16x32_bf16 v[56:59], v[100:103], a[244:247], v[56:59]
  s_add_u32 s50, s32, 8192
  ds_read_b64 v[84:85], v24 offset:1088
  v_mfma_f32_16x16x32_bf16 v[56:59], v[104:107], a[240:243], v[56:59]
  buffer_load_dwordx4 v[160:163], v30, s[24:27], s50 offen offset:0 sc1
  v_mfma_f32_16x16x32_bf16 v[56:59], v[108:111], a[236:239], v[56:59]
  ds_read_b64 v[86:87], v24 offset:1096
  v_mfma_f32_16x16x32_bf16 v[56:59], v[112:115], a[232:235], v[56:59]
  ds_read_b128 v[240:243], v25 offset:2624
  v_mfma_f32_16x16x32_bf16 v[56:59], v[116:119], a[228:231], v[56:59]
  v_mfma_f32_16x16x32_bf16 v[56:59], v[120:123], a[224:227], v[56:59]
  ds_read_b64 v[88:89], v24 offset:576
  v_mfma_f32_16x16x32_bf16 v[60:63], v[96:99], a[252:255], v[60:63]
  ds_read_b64 v[90:91], v24 offset:584
  v_mfma_f32_16x16x32_bf16 v[60:63], v[100:103], a[248:251], v[60:63]
  buffer_load_dwordx4 v[164:167], v30, s[24:27], s50 offen offset:1024 sc1
  v_mfma_f32_16x16x32_bf16 v[60:63], v[104:107], a[244:247], v[60:63]
  ds_read_b128 v[244:247], v25 offset:3136
  v_mfma_f32_16x16x32_bf16 v[60:63], v[108:111], a[240:243], v[60:63]
  ds_read_b64 v[92:93], v24 offset:64
  v_mfma_f32_16x16x32_bf16 v[60:63], v[112:115], a[236:239], v[60:63]
  v_mfma_f32_16x16x32_bf16 v[60:63], v[116:119], a[232:235], v[60:63]
  ds_read_b64 v[94:95], v24 offset:72
  v_mfma_f32_16x16x32_bf16 v[60:63], v[120:123], a[228:231], v[60:63]
  ds_read_b128 v[248:251], v25 offset:3648
  v_mfma_f32_16x16x32_bf16 v[60:63], v[124:127], a[224:227], v[60:63]
  s_waitcnt lgkmcnt(6)
  v_mfma_f32_16x16x32_bf16 v[32:35], v[64:67], v[4:7], v[32:35]
  ds_read_b64 v[96:97], v24 offset:3584
  v_mfma_f32_16x16x32_bf16 v[36:39], v[64:67], v[8:11], v[36:39]
  ds_read_b64 v[98:99], v24 offset:3592
  v_mfma_f32_16x16x32_bf16 v[36:39], v[68:71], v[4:7], v[36:39]
  buffer_load_dwordx4 v[168:171], v30, s[24:27], s50 offen offset:2048 sc1
  v_mfma_f32_16x16x32_bf16 v[40:43], v[64:67], v[12:15], v[40:43]
  ds_read_b128 a[224:227], v25 offset:0
  v_mfma_f32_16x16x32_bf16 v[40:43], v[68:71], v[8:11], v[40:43]
  ds_read_b64 v[100:101], v24 offset:3072
  v_mfma_f32_16x16x32_bf16 v[40:43], v[72:75], v[4:7], v[40:43]
  v_mfma_f32_16x16x32_bf16 v[44:47], v[64:67], v[16:19], v[44:47]
  ds_read_b64 v[102:103], v24 offset:3080
  v_mfma_f32_16x16x32_bf16 v[44:47], v[68:71], v[12:15], v[44:47]
  ds_read_b128 a[228:231], v25 offset:512
  v_mfma_f32_16x16x32_bf16 v[44:47], v[72:75], v[8:11], v[44:47]
  buffer_load_dwordx4 v[172:175], v30, s[24:27], s50 offen offset:3072 sc1
  v_mfma_f32_16x16x32_bf16 v[44:47], v[76:79], v[4:7], v[44:47]
  ds_read_b64 v[104:105], v24 offset:2560
  v_mfma_f32_16x16x32_bf16 v[48:51], v[64:67], v[20:23], v[48:51]
  ds_read_b64 v[106:107], v24 offset:2568
  v_mfma_f32_16x16x32_bf16 v[48:51], v[68:71], v[16:19], v[48:51]
  v_mfma_f32_16x16x32_bf16 v[48:51], v[72:75], v[12:15], v[48:51]
  ds_read_b128 a[232:235], v25 offset:1024
  v_mfma_f32_16x16x32_bf16 v[48:51], v[76:79], v[8:11], v[48:51]
  s_add_u32 s50, s32, 12288
  ds_read_b64 v[108:109], v24 offset:2048
  v_mfma_f32_16x16x32_bf16 v[48:51], v[80:83], v[4:7], v[48:51]
  buffer_load_dwordx4 v[176:179], v30, s[24:27], s50 offen offset:0 sc1
  v_mfma_f32_16x16x32_bf16 v[52:55], v[64:67], v[240:243], v[52:55]
  ds_read_b64 v[110:111], v24 offset:2056
  v_mfma_f32_16x16x32_bf16 v[52:55], v[68:71], v[20:23], v[52:55]
  ds_read_b128 a[236:239], v25 offset:1536
  v_mfma_f32_16x16x32_bf16 v[52:55], v[72:75], v[16:19], v[52:55]
  v_mfma_f32_16x16x32_bf16 v[52:55], v[76:79], v[12:15], v[52:55]
  ds_read_b64 v[112:113], v24 offset:1536
  v_mfma_f32_16x16x32_bf16 v[52:55], v[80:83], v[8:11], v[52:55]
  ds_read_b64 v[114:115], v24 offset:1544
  v_mfma_f32_16x16x32_bf16 v[52:55], v[84:87], v[4:7], v[52:55]
  s_waitcnt lgkmcnt(14)
  v_mfma_f32_16x16x32_bf16 v[56:59], v[64:67], v[244:247], v[56:59]
  ds_read_b128 a[240:243], v25 offset:2048
  v_mfma_f32_16x16x32_bf16 v[56:59], v[68:71], v[240:243], v[56:59]
  ds_read_b64 v[116:117], v24 offset:1024
  v_mfma_f32_16x16x32_bf16 v[56:59], v[72:75], v[20:23], v[56:59]
  buffer_load_dwordx2 v[180:181], v0, s[24:27], s50 offen offset:1024 sc1
  buffer_load_dwordx2 v[182:183], v0, s[24:27], s50 offen offset:1536 sc1
  v_mfma_f32_16x16x32_bf16 v[56:59], v[76:79], v[16:19], v[56:59]
  ds_read_b64 v[118:119], v24 offset:1032
  v_mfma_f32_16x16x32_bf16 v[56:59], v[80:83], v[12:15], v[56:59]
  ds_read_b128 a[244:247], v25 offset:2560
  v_mfma_f32_16x16x32_bf16 v[56:59], v[84:87], v[8:11], v[56:59]
  v_mfma_f32_16x16x32_bf16 v[56:59], v[88:91], v[4:7], v[56:59]
  ds_read_b64 v[120:121], v24 offset:512
  v_mfma_f32_16x16x32_bf16 v[60:63], v[64:67], v[248:251], v[60:63]
  s_add_u32 s50, s33, 8192
  ds_read_b64 v[122:123], v24 offset:520
  v_mfma_f32_16x16x32_bf16 v[60:63], v[68:71], v[244:247], v[60:63]
  buffer_load_dwordx4 v[216:219], v30, s[24:27], s50 offen offset:0 sc1
  v_mfma_f32_16x16x32_bf16 v[60:63], v[72:75], v[240:243], v[60:63]
  ds_read_b128 a[248:251], v25 offset:3072
  v_mfma_f32_16x16x32_bf16 v[60:63], v[76:79], v[20:23], v[60:63]
  ds_read_b64 v[124:125], v24 offset:0
  v_mfma_f32_16x16x32_bf16 v[60:63], v[80:83], v[16:19], v[60:63]
  v_mfma_f32_16x16x32_bf16 v[60:63], v[84:87], v[12:15], v[60:63]
  ds_read_b64 v[126:127], v24 offset:8
  v_mfma_f32_16x16x32_bf16 v[60:63], v[88:91], v[8:11], v[60:63]
  ds_read_b128 a[252:255], v25 offset:3584
  v_mfma_f32_16x16x32_bf16 v[60:63], v[92:95], v[4:7], v[60:63]
  s_waitcnt lgkmcnt(6)
  v_mfma_f32_16x16x32_bf16 v[32:35], v[96:99], a[224:227], v[32:35]
  v_mfma_f32_16x16x32_bf16 v[36:39], v[96:99], a[228:231], v[36:39]
  v_mfma_f32_16x16x32_bf16 v[36:39], v[100:103], a[224:227], v[36:39]
  buffer_load_dwordx4 v[220:223], v30, s[24:27], s50 offen offset:1024 sc1
  v_mfma_f32_16x16x32_bf16 v[40:43], v[96:99], a[232:235], v[40:43]
  v_mfma_f32_16x16x32_bf16 v[40:43], v[100:103], a[228:231], v[40:43]
  v_mfma_f32_16x16x32_bf16 v[40:43], v[104:107], a[224:227], v[40:43]
  v_mfma_f32_16x16x32_bf16 v[44:47], v[96:99], a[236:239], v[44:47]
  v_mfma_f32_16x16x32_bf16 v[44:47], v[100:103], a[232:235], v[44:47]
  ds_write_b128 v26, v[32:35] offset:0
  v_mfma_f32_16x16x32_bf16 v[44:47], v[104:107], a[228:231], v[44:47]
  buffer_load_dwordx4 v[224:227], v30, s[24:27], s50 offen offset:2048 sc1
  v_mfma_f32_16x16x32_bf16 v[44:47], v[108:111], a[224:227], v[44:47]
  v_mfma_f32_16x16x32_bf16 v[48:51], v[96:99], a[240:243], v[48:51]
  v_mfma_f32_16x16x32_bf16 v[48:51], v[100:103], a[236:239], v[48:51]
  ds_write_b128 v26, v[36:39] offset:1024
  v_mfma_f32_16x16x32_bf16 v[48:51], v[104:107], a[232:235], v[48:51]
  v_mfma_f32_16x16x32_bf16 v[48:51], v[108:111], a[228:231], v[48:51]
  v_mfma_f32_16x16x32_bf16 v[48:51], v[112:115], a[224:227], v[48:51]
  buffer_load_dwordx4 v[228:231], v30, s[24:27], s50 offen offset:3072 sc1
  v_mfma_f32_16x16x32_bf16 v[52:55], v[96:99], a[244:247], v[52:55]
  v_mfma_f32_16x16x32_bf16 v[52:55], v[100:103], a[240:243], v[52:55]
  ds_write_b128 v26, v[40:43] offset:2048
  v_mfma_f32_16x16x32_bf16 v[52:55], v[104:107], a[236:239], v[52:55]
  v_mfma_f32_16x16x32_bf16 v[52:55], v[108:111], a[232:235], v[52:55]
  v_mfma_f32_16x16x32_bf16 v[52:55], v[112:115], a[228:231], v[52:55]
  v_mfma_f32_16x16x32_bf16 v[52:55], v[116:119], a[224:227], v[52:55]
  s_waitcnt lgkmcnt(3)
  v_mfma_f32_16x16x32_bf16 v[56:59], v[96:99], a[248:251], v[56:59]
  v_mfma_f32_16x16x32_bf16 v[56:59], v[100:103], a[244:247], v[56:59]
  s_add_u32 s50, s33, 12288
  ds_write_b128 v26, v[44:47] offset:3072
  v_mfma_f32_16x16x32_bf16 v[56:59], v[104:107], a[240:243], v[56:59]
  buffer_load_dwordx4 v[232:235], v30, s[24:27], s50 offen offset:0 sc1
  v_mfma_f32_16x16x32_bf16 v[56:59], v[108:111], a[236:239], v[56:59]
  v_mfma_f32_16x16x32_bf16 v[56:59], v[112:115], a[232:235], v[56:59]
  v_mfma_f32_16x16x32_bf16 v[56:59], v[116:119], a[228:231], v[56:59]
  v_mfma_f32_16x16x32_bf16 v[56:59], v[120:123], a[224:227], v[56:59]
  v_mfma_f32_16x16x32_bf16 v[60:63], v[96:99], a[252:255], v[60:63]
  v_mfma_f32_16x16x32_bf16 v[60:63], v[100:103], a[248:251], v[60:63]
  buffer_load_dwordx2 v[236:237], v0, s[24:27], s50 offen offset:1024 sc1
  buffer_load_dwordx2 v[238:239], v0, s[24:27], s50 offen offset:1536 sc1
  ds_write_b128 v26, v[48:51] offset:4096
  v_mfma_f32_16x16x32_bf16 v[60:63], v[104:107], a[244:247], v[60:63]
  v_mfma_f32_16x16x32_bf16 v[60:63], v[108:111], a[240:243], v[60:63]
  v_mfma_f32_16x16x32_bf16 v[60:63], v[112:115], a[236:239], v[60:63]
  v_mfma_f32_16x16x32_bf16 v[60:63], v[116:119], a[232:235], v[60:63]
  v_mfma_f32_16x16x32_bf16 v[60:63], v[120:123], a[228:231], v[60:63]
  v_mfma_f32_16x16x32_bf16 v[60:63], v[124:127], a[224:227], v[60:63]
  ds_write_b128 v26, v[52:55] offset:5120
  ds_write_b128 v26, v[56:59] offset:6144
  s_nop 5
  ds_write_b128 v26, v[60:63] offset:7168
  s_lshl_b32 s3, s4, 11
  s_add_u32 s3, s3, 116224
  v_lshl_add_u32 v25, v1, 4, s3
  s_lshl_b32 s86, s2, 13
  s_lshl_b32 s10, s4, 11
  s_add_u32 s86, s86, s10
  s_add_u32 s86, s86, 2228224
  v_lshlrev_b32 v26, 4, v1
  s_add_u32 s50, s34, 0
  buffer_load_dwordx4 v[96:99], v30, s[24:27], s50 offen offset:0 sc1
  buffer_load_dwordx4 v[100:103], v30, s[24:27], s50 offen offset:1024 sc1
  buffer_load_dwordx4 v[104:107], v30, s[24:27], s50 offen offset:2048 sc1
  s_waitcnt lgkmcnt(0)
  s_barrier
  ds_read_b128 v[64:67], v25 offset:0
  ds_read_b128 v[68:71], v25 offset:8192
  ds_read_b128 v[72:75], v25 offset:16384
  ds_read_b128 v[76:79], v25 offset:24576
  ds_read_b128 v[80:83], v25 offset:1024
  ds_read_b128 v[84:87], v25 offset:9216
  ds_read_b128 v[88:91], v25 offset:17408
  ds_read_b128 v[92:95], v25 offset:25600
  buffer_load_dwordx4 v[108:111], v30, s[24:27], s50 offen offset:3072 sc1
  s_add_u32 s50, s34, 4096
  buffer_load_dwordx4 v[112:115], v30, s[24:27], s50 offen offset:0 sc1
  s_waitcnt lgkmcnt(4)
  v_add_f32 v64, v64, v68
  v_add_f32 v72, v72, v76
  v_add_f32 v65, v65, v69
  v_add_f32 v73, v73, v77
  v_add_f32 v66, v66, v70
  v_add_f32 v74, v74, v78
  v_add_f32 v67, v67, v71
  v_add_f32 v75, v75, v79
  v_cvt_pk_bf16_f32 v68, v64, v72
  v_cvt_pk_bf16_f32 v69, v65, v73
  v_cvt_pk_bf16_f32 v70, v66, v74
  v_cvt_pk_bf16_f32 v71, v67, v75
  buffer_store_dwordx4 v[68:71], v26, s[24:27], s86 offen offset:0 sc1
  s_waitcnt lgkmcnt(0)
  v_add_f32 v80, v80, v84
  v_add_f32 v88, v88, v92
  v_add_f32 v81, v81, v85
  v_add_f32 v89, v89, v93
  v_add_f32 v82, v82, v86
  v_add_f32 v90, v90, v94
  v_add_f32 v83, v83, v87
  v_add_f32 v91, v91, v95
  v_cvt_pk_bf16_f32 v84, v80, v88
  v_cvt_pk_bf16_f32 v85, v81, v89
  v_cvt_pk_bf16_f32 v86, v82, v90
  v_cvt_pk_bf16_f32 v87, v83, v91
  buffer_store_dwordx4 v[84:87], v26, s[24:27], s86 offen offset:1024 sc1
  buffer_load_dwordx4 v[116:119], v30, s[24:27], s50 offen offset:1024 sc1
  buffer_load_dwordx2 v[120:121], v0, s[24:27], s50 offen offset:2048 sc1
  buffer_load_dwordx2 v[122:123], v0, s[24:27], s50 offen offset:2560 sc1
  buffer_load_dwordx4 v[124:127], v30, s[24:27], s50 offen offset:3072 sc1
  s_lshl_b32 s3, s8, 6
  s_lshl_b32 s10, s4, 4
  s_add_u32 s3, s3, s10
  v_add_u32 v4, s3, v2
  s_lshl_b32 s10, s9, 6
  v_lshl_add_u32 v5, v3, 2, s10
  s_waitcnt vmcnt(32)
  v_mfma_f32_16x16x32_bf16 v[32:35], a[0:3], v[128:131], 0
  v_lshlrev_b32 v7, 12, v5
  v_mfma_f32_16x16x32_bf16 v[36:39], a[4:7], v[128:131], 0
  v_lshl_add_u32 v7, v4, 2, v7
  v_mfma_f32_16x16x32_bf16 v[40:43], a[8:11], v[128:131], 0
  s_add_u32 s50, s35, 0
  v_add_u32 v7, 2228224, v7
  v_mfma_f32_16x16x32_bf16 v[44:47], a[12:15], v[128:131], 0
  buffer_load_dwordx4 v[128:131], v30, s[24:27], s50 offen offset:0 sc1
  v_mfma_f32_16x16x32_bf16 v[32:35], a[16:19], v[132:135], v[32:35]
  s_lshl_b32 s11, s9, 10
  v_mfma_f32_16x16x32_bf16 v[36:39], a[20:23], v[132:135], v[36:39]
  s_add_u32 s11, s11, 40960
  v_mfma_f32_16x16x32_bf16 v[40:43], a[24:27], v[132:135], v[40:43]
  v_and_b32 v8, 31, v1
  v_mfma_f32_16x16x32_bf16 v[44:47], a[28:31], v[132:135], v[44:47]
  s_waitcnt vmcnt(31)
  v_mfma_f32_16x16x32_bf16 v[32:35], a[32:35], v[136:139], v[32:35]
  buffer_load_dwordx4 v[132:135], v30, s[24:27], s50 offen offset:1024 sc1
  v_mfma_f32_16x16x32_bf16 v[36:39], a[36:39], v[136:139], v[36:39]
  v_lshlrev_b32 v8, 5, v8
  v_mfma_f32_16x16x32_bf16 v[40:43], a[40:43], v[136:139], v[40:43]
  v_add_u32 v8, s11, v8
  v_mfma_f32_16x16x32_bf16 v[44:47], a[44:47], v[136:139], v[44:47]
  buffer_load_dwordx4 v[136:139], v30, s[24:27], s50 offen offset:2048 sc1
  v_mfma_f32_16x16x32_bf16 v[32:35], a[48:51], v[140:143], v[32:35]
  v_lshrrev_b32 v28, 1, v3
  v_mfma_f32_16x16x32_bf16 v[36:39], a[52:55], v[140:143], v[36:39]
  v_and_b32 v29, 7, v2
  v_mfma_f32_16x16x32_bf16 v[40:43], a[56:59], v[140:143], v[40:43]
  v_xor_b32 v28, v28, v29
  v_mfma_f32_16x16x32_bf16 v[44:47], a[60:63], v[140:143], v[44:47]
  s_waitcnt vmcnt(31)
  v_mfma_f32_16x16x32_bf16 v[32:35], a[64:67], v[144:147], v[32:35]
  buffer_load_dwordx4 v[140:143], v30, s[24:27], s50 offen offset:3072 sc1
  v_mfma_f32_16x16x32_bf16 v[36:39], a[68:71], v[144:147], v[36:39]
  v_lshlrev_b32 v28, 4, v28
  v_mfma_f32_16x16x32_bf16 v[40:43], a[72:75], v[144:147], v[40:43]
  v_lshl_add_u32 v28, v2, 7, v28
  v_mfma_f32_16x16x32_bf16 v[44:47], a[76:79], v[144:147], v[44:47]
  v_and_b32 v29, 1, v3
  v_mfma_f32_16x16x32_bf16 v[32:35], a[80:83], v[148:151], v[32:35]
  v_lshl_add_u32 v28, v29, 3, v28
  v_mfma_f32_16x16x32_bf16 v[36:39], a[84:87], v[148:151], v[36:39]
  s_lshl_b32 s11, s4, 11
  v_mfma_f32_16x16x32_bf16 v[40:43], a[88:91], v[148:151], v[40:43]
  s_add_u32 s11, s11, 152576
  v_mfma_f32_16x16x32_bf16 v[44:47], a[92:95], v[148:151], v[44:47]
  v_add_u32 v6, s11, v28
  s_waitcnt vmcnt(29)
  v_mfma_f32_16x16x32_bf16 v[32:35], a[96:99], v[152:155], v[32:35]
  v_lshlrev_b32 v5, 4, v3
  v_mfma_f32_16x16x32_bf16 v[36:39], a[100:103], v[152:155], v[36:39]
  v_add_u32 v5, 152064, v5
  v_mfma_f32_16x16x32_bf16 v[40:43], a[104:107], v[152:155], v[40:43]
  v_sub_f32 v11, 1.0, v31
  v_mfma_f32_16x16x32_bf16 v[44:47], a[108:111], v[152:155], v[44:47]
  v_cvt_pk_bf16_f32 v11, v11, v11
  v_mfma_f32_16x16x32_bf16 v[32:35], a[112:115], v[156:159], v[32:35]
  v_and_b32 v11, 0xffff0000, v11
  v_mfma_f32_16x16x32_bf16 v[36:39], a[116:119], v[156:159], v[36:39]
  v_xor_b32 v28, 0, v6
  v_mfma_f32_16x16x32_bf16 v[40:43], a[120:123], v[156:159], v[40:43]
  ds_read_b64 v[248:249], v28
  v_mfma_f32_16x16x32_bf16 v[44:47], a[124:127], v[156:159], v[44:47]
  ds_read_b64 v[250:251], v5 offset:0
  s_waitcnt vmcnt(27)
  v_mfma_f32_16x16x32_bf16 v[32:35], a[128:131], v[160:163], v[32:35]
  ds_read_b64 v[252:253], v5 offset:256
  v_mfma_f32_16x16x32_bf16 v[36:39], a[132:135], v[160:163], v[36:39]
  v_mfma_f32_16x16x32_bf16 v[40:43], a[136:139], v[160:163], v[40:43]
  s_add_u32 s50, s34, 8192
  v_mfma_f32_16x16x32_bf16 v[44:47], a[140:143], v[160:163], v[44:47]
  buffer_load_dwordx4 v[160:163], v30, s[24:27], s50 offen offset:0 sc1
  v_mfma_f32_16x16x32_bf16 v[32:35], a[144:147], v[164:167], v[32:35]
  s_waitcnt lgkmcnt(0)
  v_mfma_f32_16x16x32_bf16 v[36:39], a[148:151], v[164:167], v[36:39]
  v_lshlrev_b32 v29, 16, v248
  v_mfma_f32_16x16x32_bf16 v[40:43], a[152:155], v[164:167], v[40:43]
  v_mul_f32 v29, v29, v250
  v_mfma_f32_16x16x32_bf16 v[44:47], a[156:159], v[164:167], v[44:47]
  s_waitcnt vmcnt(26)
  v_mfma_f32_16x16x32_bf16 v[32:35], a[160:163], v[168:171], v[32:35]
  buffer_load_dwordx4 v[164:167], v30, s[24:27], s50 offen offset:1024 sc1
  v_mfma_f32_16x16x32_bf16 v[36:39], a[164:167], v[168:171], v[36:39]
  v_mul_f32 v12, v11, v252
  v_mfma_f32_16x16x32_bf16 v[40:43], a[168:171], v[168:171], v[40:43]
  v_fma_f32 v12, v31, v29, v12
  v_mfma_f32_16x16x32_bf16 v[44:47], a[172:175], v[168:171], v[44:47]
  buffer_load_dwordx4 v[168:171], v30, s[24:27], s50 offen offset:2048 sc1
  v_mfma_f32_16x16x32_bf16 v[32:35], a[176:179], v[172:175], v[32:35]
  v_and_b32 v29, 0xffff0000, v248
  v_mfma_f32_16x16x32_bf16 v[36:39], a[180:183], v[172:175], v[36:39]
  v_mul_f32 v29, v29, v251
  v_mfma_f32_16x16x32_bf16 v[40:43], a[184:187], v[172:175], v[40:43]
  v_mul_f32 v13, v11, v253
  v_mfma_f32_16x16x32_bf16 v[44:47], a[188:191], v[172:175], v[44:47]
  s_waitcnt vmcnt(25)
  v_mfma_f32_16x16x32_bf16 v[32:35], a[192:195], v[176:179], v[32:35]
  buffer_load_dwordx4 v[172:175], v30, s[24:27], s50 offen offset:3072 sc1
  v_mfma_f32_16x16x32_bf16 v[36:39], a[196:199], v[176:179], v[36:39]
  v_fma_f32 v13, v31, v29, v13
  v_mfma_f32_16x16x32_bf16 v[40:43], a[200:203], v[176:179], v[40:43]
  s_add_u32 s50, s34, 12288
  ds_read_b64 v[250:251], v5 offset:8
  v_mfma_f32_16x16x32_bf16 v[44:47], a[204:207], v[176:179], v[44:47]
  buffer_load_dwordx4 v[176:179], v30, s[24:27], s50 offen offset:0 sc1
  v_mfma_f32_16x16x32_bf16 v[32:35], a[208:211], v[180:183], v[32:35]
  ds_read_b64 v[252:253], v5 offset:264
  v_mfma_f32_16x16x32_bf16 v[36:39], a[212:215], v[180:183], v[36:39]
  v_mfma_f32_16x16x32_bf16 v[40:43], a[216:219], v[180:183], v[40:43]
  v_mfma_f32_16x16x32_bf16 v[44:47], a[220:223], v[180:183], v[44:47]
  buffer_load_dwordx2 v[180:181], v0, s[24:27], s50 offen offset:1024 sc1
  buffer_load_dwordx2 v[182:183], v0, s[24:27], s50 offen offset:1536 sc1
  s_waitcnt vmcnt(52)
  v_mfma_f32_16x16x32_bf16 v[48:51], a[0:3], v[184:187], 0
  s_waitcnt lgkmcnt(0)
  v_mfma_f32_16x16x32_bf16 v[52:55], a[4:7], v[184:187], 0
  v_lshlrev_b32 v29, 16, v249
  v_mfma_f32_16x16x32_bf16 v[56:59], a[8:11], v[184:187], 0
  v_mul_f32 v29, v29, v250
  v_mfma_f32_16x16x32_bf16 v[60:63], a[12:15], v[184:187], 0
  v_mul_f32 v14, v11, v252
  v_mfma_f32_16x16x32_bf16 v[48:51], a[16:19], v[188:191], v[48:51]
  v_fma_f32 v14, v31, v29, v14
  v_mfma_f32_16x16x32_bf16 v[52:55], a[20:23], v[188:191], v[52:55]
  s_add_u32 s3, s4, 1
  s_and_b32 s3, s3, 3
  s_mul_i32 s3, s3, 12288
  s_add_u32 s3, s3, 0
  v_lshl_add_u32 v10, v1, 4, s3
  v_mfma_f32_16x16x32_bf16 v[56:59], a[24:27], v[188:191], v[56:59]
  v_and_b32 v29, 0xffff0000, v249
  v_mfma_f32_16x16x32_bf16 v[60:63], a[28:31], v[188:191], v[60:63]
  v_mul_f32 v29, v29, v251
  s_waitcnt vmcnt(50)
  v_mfma_f32_16x16x32_bf16 v[48:51], a[32:35], v[192:195], v[48:51]
  v_mul_f32 v15, v11, v253
  v_mfma_f32_16x16x32_bf16 v[52:55], a[36:39], v[192:195], v[52:55]
  ds_write_b128 v10, v[32:35] offset:0
  v_mfma_f32_16x16x32_bf16 v[56:59], a[40:43], v[192:195], v[56:59]
  v_fma_f32 v15, v31, v29, v15
  v_mfma_f32_16x16x32_bf16 v[60:63], a[44:47], v[192:195], v[60:63]
  v_xor_b32 v28, 32, v6
  v_mfma_f32_16x16x32_bf16 v[48:51], a[48:51], v[196:199], v[48:51]
  ds_read_b64 v[248:249], v28
  v_mfma_f32_16x16x32_bf16 v[52:55], a[52:55], v[196:199], v[52:55]
  ds_write_b128 v10, v[36:39] offset:1024
  v_mfma_f32_16x16x32_bf16 v[56:59], a[56:59], v[196:199], v[56:59]
  ds_read_b64 v[250:251], v5 offset:64
  v_mfma_f32_16x16x32_bf16 v[60:63], a[60:63], v[196:199], v[60:63]
  ds_read_b64 v[252:253], v5 offset:320
  s_waitcnt vmcnt(15)
  s_barrier
  s_lshl_b32 s3, s2, 5
  s_add_u32 s3, s3, 40960
  v_mov_b32 v240, s72
  v_mov_b32 v241, 0
  s_mov_b64 s[74:75], exec
  s_mov_b64 exec, 1
  buffer_store_dword v240, v241, s[24:27], s3 offen sc1
  s_mov_b64 exec, s[74:75]
  s_waitcnt vmcnt(49)
  v_mfma_f32_16x16x32_bf16 v[48:51], a[64:67], v[200:203], v[48:51]
  v_mfma_f32_16x16x32_bf16 v[52:55], a[68:71], v[200:203], v[52:55]
  ds_write_b128 v10, v[40:43] offset:2048
  v_mfma_f32_16x16x32_bf16 v[56:59], a[72:75], v[200:203], v[56:59]
  s_add_u32 s50, s35, 4096
  v_mfma_f32_16x16x32_bf16 v[60:63], a[76:79], v[200:203], v[60:63]
  buffer_load_dwordx4 v[200:203], v30, s[24:27], s50 offen offset:0 sc1
  v_mfma_f32_16x16x32_bf16 v[48:51], a[80:83], v[204:207], v[48:51]
  s_waitcnt lgkmcnt(1)
  v_mfma_f32_16x16x32_bf16 v[52:55], a[84:87], v[204:207], v[52:55]
  ds_write_b128 v10, v[44:47] offset:3072
  v_mfma_f32_16x16x32_bf16 v[56:59], a[88:91], v[204:207], v[56:59]
  v_lshlrev_b32 v29, 16, v248
  v_mfma_f32_16x16x32_bf16 v[60:63], a[92:95], v[204:207], v[60:63]
  s_waitcnt vmcnt(47)
  v_mfma_f32_16x16x32_bf16 v[48:51], a[96:99], v[208:211], v[48:51]
  buffer_load_dwordx4 v[204:207], v30, s[24:27], s50 offen offset:1024 sc1
  v_mfma_f32_16x16x32_bf16 v[52:55], a[100:103], v[208:211], v[52:55]
  v_mul_f32 v29, v29, v250
  v_mfma_f32_16x16x32_bf16 v[56:59], a[104:107], v[208:211], v[56:59]
  v_mul_f32 v16, v11, v252
  v_mfma_f32_16x16x32_bf16 v[60:63], a[108:111], v[208:211], v[60:63]
  buffer_load_dwordx2 v[208:209], v0, s[24:27], s50 offen offset:2048 sc1
  buffer_load_dwordx2 v[210:211], v0, s[24:27], s50 offen offset:2560 sc1
  v_mfma_f32_16x16x32_bf16 v[48:51], a[112:115], v[212:215], v[48:51]
  v_fma_f32 v16, v31, v29, v16
  v_mfma_f32_16x16x32_bf16 v[52:55], a[116:119], v[212:215], v[52:55]
  v_and_b32 v29, 0xffff0000, v248
  v_mfma_f32_16x16x32_bf16 v[56:59], a[120:123], v[212:215], v[56:59]
  v_mul_f32 v29, v29, v251
  v_mfma_f32_16x16x32_bf16 v[60:63], a[124:127], v[212:215], v[60:63]
  s_waitcnt vmcnt(32)
  v_mfma_f32_16x16x32_bf16 v[48:51], a[128:131], v[216:219], v[48:51]
  buffer_load_dwordx4 v[212:215], v30, s[24:27], s50 offen offset:3072 sc1
  v_mfma_f32_16x16x32_bf16 v[52:55], a[132:135], v[216:219], v[52:55]
  v_mul_f32 v17, v11, v253
  v_mfma_f32_16x16x32_bf16 v[56:59], a[136:139], v[216:219], v[56:59]
  s_add_u32 s50, s35, 8192
  v_fma_f32 v17, v31, v29, v17
  v_mfma_f32_16x16x32_bf16 v[60:63], a[140:143], v[216:219], v[60:63]
  buffer_load_dwordx4 v[216:219], v30, s[24:27], s50 offen offset:0 sc1
  v_mfma_f32_16x16x32_bf16 v[48:51], a[144:147], v[220:223], v[48:51]
  ds_read_b64 v[250:251], v5 offset:72
  v_mfma_f32_16x16x32_bf16 v[52:55], a[148:151], v[220:223], v[52:55]
  ds_read_b64 v[252:253], v5 offset:328
  v_mfma_f32_16x16x32_bf16 v[56:59], a[152:155], v[220:223], v[56:59]
  v_mfma_f32_16x16x32_bf16 v[60:63], a[156:159], v[220:223], v[60:63]
  s_waitcnt vmcnt(32)
  v_mfma_f32_16x16x32_bf16 v[48:51], a[160:163], v[224:227], v[48:51]
  buffer_load_dwordx4 v[220:223], v30, s[24:27], s50 offen offset:1024 sc1
  v_mfma_f32_16x16x32_bf16 v[52:55], a[164:167], v[224:227], v[52:55]
  v_mfma_f32_16x16x32_bf16 v[56:59], a[168:171], v[224:227], v[56:59]
  s_waitcnt lgkmcnt(0)
  v_mfma_f32_16x16x32_bf16 v[60:63], a[172:175], v[224:227], v[60:63]
  buffer_load_dwordx4 v[224:227], v30, s[24:27], s50 offen offset:2048 sc1
  v_mfma_f32_16x16x32_bf16 v[48:51], a[176:179], v[228:231], v[48:51]
  v_lshlrev_b32 v29, 16, v249
  v_mfma_f32_16x16x32_bf16 v[52:55], a[180:183], v[228:231], v[52:55]
  v_mul_f32 v29, v29, v250
  v_mfma_f32_16x16x32_bf16 v[56:59], a[184:187], v[228:231], v[56:59]
  v_mul_f32 v18, v11, v252
  v_mfma_f32_16x16x32_bf16 v[60:63], a[188:191], v[228:231], v[60:63]
  s_waitcnt vmcnt(31)
  v_mfma_f32_16x16x32_bf16 v[48:51], a[192:195], v[232:235], v[48:51]
  buffer_load_dwordx4 v[228:231], v30, s[24:27], s50 offen offset:3072 sc1
  v_mfma_f32_16x16x32_bf16 v[52:55], a[196:199], v[232:235], v[52:55]
  v_fma_f32 v18, v31, v29, v18
  v_mfma_f32_16x16x32_bf16 v[56:59], a[200:203], v[232:235], v[56:59]
  s_add_u32 s50, s35, 12288
  v_and_b32 v29, 0xffff0000, v249
  v_mfma_f32_16x16x32_bf16 v[60:63], a[204:207], v[232:235], v[60:63]
  buffer_load_dwordx4 v[232:235], v30, s[24:27], s50 offen offset:0 sc1
  v_mfma_f32_16x16x32_bf16 v[48:51], a[208:211], v[236:239], v[48:51]
  v_mul_f32 v29, v29, v251
  v_mfma_f32_16x16x32_bf16 v[52:55], a[212:215], v[236:239], v[52:55]
  v_mul_f32 v19, v11, v253
  v_mfma_f32_16x16x32_bf16 v[56:59], a[216:219], v[236:239], v[56:59]
  v_fma_f32 v19, v31, v29, v19
  v_mfma_f32_16x16x32_bf16 v[60:63], a[220:223], v[236:239], v[60:63]
  buffer_load_dwordx2 v[236:237], v0, s[24:27], s50 offen offset:1024 sc1
  buffer_load_dwordx2 v[238:239], v0, s[24:27], s50 offen offset:1536 sc1
  s_waitcnt vmcnt(33)
  v_mfma_f32_16x16x32_bf16 v[64:67], a[0:3], v[96:99], 0
  v_xor_b32 v28, 64, v6
  v_mfma_f32_16x16x32_bf16 v[68:71], a[4:7], v[96:99], 0
  ds_read_b64 v[248:249], v28
  ds_read_b64 v[250:251], v5 offset:128
  v_mfma_f32_16x16x32_bf16 v[72:75], a[8:11], v[96:99], 0
  ds_read_b64 v[252:253], v5 offset:384
  v_mfma_f32_16x16x32_bf16 v[76:79], a[12:15], v[96:99], 0
  v_mfma_f32_16x16x32_bf16 v[64:67], a[16:19], v[100:103], v[64:67]
  v_mfma_f32_16x16x32_bf16 v[68:71], a[20:23], v[100:103], v[68:71]
  s_add_u32 s3, s4, 2
  s_and_b32 s3, s3, 3
  s_mul_i32 s3, s3, 12288
  s_add_u32 s3, s3, 4096
  v_lshl_add_u32 v10, v1, 4, s3
  v_mfma_f32_16x16x32_bf16 v[72:75], a[24:27], v[100:103], v[72:75]
  s_waitcnt lgkmcnt(0)
  v_mfma_f32_16x16x32_bf16 v[76:79], a[28:31], v[100:103], v[76:79]
  v_lshlrev_b32 v29, 16, v248
  s_waitcnt vmcnt(31)
  v_mfma_f32_16x16x32_bf16 v[64:67], a[32:35], v[104:107], v[64:67]
  v_mul_f32 v29, v29, v250
  v_mfma_f32_16x16x32_bf16 v[68:71], a[36:39], v[104:107], v[68:71]
  ds_write_b128 v10, v[48:51] offset:0
  v_mfma_f32_16x16x32_bf16 v[72:75], a[40:43], v[104:107], v[72:75]
  v_mul_f32 v20, v11, v252
  v_mfma_f32_16x16x32_bf16 v[76:79], a[44:47], v[104:107], v[76:79]
  v_fma_f32 v20, v31, v29, v20
  v_mfma_f32_16x16x32_bf16 v[64:67], a[48:51], v[108:111], v[64:67]
  v_and_b32 v29, 0xffff0000, v248
  v_mfma_f32_16x16x32_bf16 v[68:71], a[52:55], v[108:111], v[68:71]
  ds_write_b128 v10, v[52:55] offset:1024
  v_mfma_f32_16x16x32_bf16 v[72:75], a[56:59], v[108:111], v[72:75]
  v_mul_f32 v29, v29, v251
  v_mfma_f32_16x16x32_bf16 v[76:79], a[60:63], v[108:111], v[76:79]
  v_mul_f32 v21, v11, v253
  s_waitcnt vmcnt(27)
  v_mfma_f32_16x16x32_bf16 v[64:67], a[64:67], v[112:115], v[64:67]
  v_fma_f32 v21, v31, v29, v21
  v_mfma_f32_16x16x32_bf16 v[68:71], a[68:71], v[112:115], v[68:71]
  ds_write_b128 v10, v[56:59] offset:2048
  v_mfma_f32_16x16x32_bf16 v[72:75], a[72:75], v[112:115], v[72:75]
  ds_read_b64 v[250:251], v5 offset:136
  v_mfma_f32_16x16x32_bf16 v[76:79], a[76:79], v[112:115], v[76:79]
  ds_read_b64 v[252:253], v5 offset:392
  v_mfma_f32_16x16x32_bf16 v[64:67], a[80:83], v[116:119], v[64:67]
  v_mfma_f32_16x16x32_bf16 v[68:71], a[84:87], v[116:119], v[68:71]
  ds_write_b128 v10, v[60:63] offset:3072
  v_mfma_f32_16x16x32_bf16 v[72:75], a[88:91], v[116:119], v[72:75]
  v_mfma_f32_16x16x32_bf16 v[76:79], a[92:95], v[116:119], v[76:79]
  s_waitcnt lgkmcnt(1)
  s_waitcnt vmcnt(24)
  v_mfma_f32_16x16x32_bf16 v[64:67], a[96:99], v[120:123], v[64:67]
  v_lshlrev_b32 v29, 16, v249
  v_mfma_f32_16x16x32_bf16 v[68:71], a[100:103], v[120:123], v[68:71]
  v_mul_f32 v29, v29, v250
  v_mul_f32 v22, v11, v252
  v_mfma_f32_16x16x32_bf16 v[72:75], a[104:107], v[120:123], v[72:75]
  v_fma_f32 v22, v31, v29, v22
  v_mfma_f32_16x16x32_bf16 v[76:79], a[108:111], v[120:123], v[76:79]
  v_and_b32 v29, 0xffff0000, v249
  v_mfma_f32_16x16x32_bf16 v[64:67], a[112:115], v[124:127], v[64:67]
  v_mul_f32 v29, v29, v251
  v_mfma_f32_16x16x32_bf16 v[68:71], a[116:119], v[124:127], v[68:71]
  v_mul_f32 v23, v11, v253
  v_fma_f32 v23, v31, v29, v23
  v_mfma_f32_16x16x32_bf16 v[72:75], a[120:123], v[124:127], v[72:75]
  v_xor_b32 v28, 96, v6
  v_mfma_f32_16x16x32_bf16 v[76:79], a[124:127], v[124:127], v[76:79]
  ds_read_b64 v[248:249], v28
  s_waitcnt vmcnt(18)
  v_mfma_f32_16x16x32_bf16 v[64:67], a[128:131], v[160:163], v[64:67]
  ds_read_b64 v[250:251], v5 offset:192
  v_mfma_f32_16x16x32_bf16 v[68:71], a[132:135], v[160:163], v[68:71]
  ds_read_b64 v[252:253], v5 offset:448
  v_mfma_f32_16x16x32_bf16 v[72:75], a[136:139], v[160:163], v[72:75]
  v_mfma_f32_16x16x32_bf16 v[76:79], a[140:143], v[160:163], v[76:79]
  s_waitcnt lgkmcnt(0)
  v_mfma_f32_16x16x32_bf16 v[64:67], a[144:147], v[164:167], v[64:67]
  v_lshlrev_b32 v29, 16, v248
  v_mfma_f32_16x16x32_bf16 v[68:71], a[148:151], v[164:167], v[68:71]
  v_mul_f32 v29, v29, v250
  v_mul_f32 v24, v11, v252
  v_mfma_f32_16x16x32_bf16 v[72:75], a[152:155], v[164:167], v[72:75]
  v_fma_f32 v24, v31, v29, v24
  v_mfma_f32_16x16x32_bf16 v[76:79], a[156:159], v[164:167], v[76:79]
  v_and_b32 v29, 0xffff0000, v248
  s_waitcnt vmcnt(16)
  v_mfma_f32_16x16x32_bf16 v[64:67], a[160:163], v[168:171], v[64:67]
  v_mul_f32 v29, v29, v251
  v_mfma_f32_16x16x32_bf16 v[68:71], a[164:167], v[168:171], v[68:71]
  v_mul_f32 v25, v11, v253
  v_fma_f32 v25, v31, v29, v25
  v_mfma_f32_16x16x32_bf16 v[72:75], a[168:171], v[168:171], v[72:75]
  ds_read_b64 v[250:251], v5 offset:200
  v_mfma_f32_16x16x32_bf16 v[76:79], a[172:175], v[168:171], v[76:79]
  ds_read_b64 v[252:253], v5 offset:456
  v_mfma_f32_16x16x32_bf16 v[64:67], a[176:179], v[172:175], v[64:67]
  v_mfma_f32_16x16x32_bf16 v[68:71], a[180:183], v[172:175], v[68:71]
  s_waitcnt lgkmcnt(0)
  v_mfma_f32_16x16x32_bf16 v[72:75], a[184:187], v[172:175], v[72:75]
  v_lshlrev_b32 v29, 16, v249
  v_mfma_f32_16x16x32_bf16 v[76:79], a[188:191], v[172:175], v[76:79]
  v_mul_f32 v29, v29, v250
  s_waitcnt vmcnt(13)
  v_mfma_f32_16x16x32_bf16 v[64:67], a[192:195], v[176:179], v[64:67]
  v_mul_f32 v26, v11, v252
  v_mfma_f32_16x16x32_bf16 v[68:71], a[196:199], v[176:179], v[68:71]
  v_fma_f32 v26, v31, v29, v26
  v_and_b32 v29, 0xffff0000, v249
  v_mfma_f32_16x16x32_bf16 v[72:75], a[200:203], v[176:179], v[72:75]
  v_mul_f32 v29, v29, v251
  v_mfma_f32_16x16x32_bf16 v[76:79], a[204:207], v[176:179], v[76:79]
  v_mul_f32 v27, v11, v253
  v_mfma_f32_16x16x32_bf16 v[64:67], a[208:211], v[180:183], v[64:67]
  v_fma_f32 v27, v31, v29, v27
  v_mfma_f32_16x16x32_bf16 v[68:71], a[212:215], v[180:183], v[68:71]
  buffer_load_dword v9, v8, s[24:27], 0 offen sc1
  v_mfma_f32_16x16x32_bf16 v[72:75], a[216:219], v[180:183], v[72:75]
  v_mfma_f32_16x16x32_bf16 v[76:79], a[220:223], v[180:183], v[76:79]
  s_waitcnt vmcnt(0)
  v_cmp_ne_u32 vcc, s72, v9
  s_nop 0
  s_cmp_eq_u64 vcc, 0
  s_cbranch_scc1 L_ok_Y
  s_mov_b32 s92, 400000
L_poll_Y:
  s_sleep 2
  buffer_load_dword v9, v8, s[24:27], 0 offen sc1
  s_waitcnt vmcnt(0)
  v_cmp_ne_u32 vcc, s72, v9
  s_sub_u32 s92, s92, 1
  s_cmp_eq_u32 s92, 0
  s_cbranch_scc1 L_ok_Y
  s_cmp_lg_u64 vcc, 0
  s_cbranch_scc1 L_poll_Y
L_ok_Y:
  s_waitcnt vmcnt(23)
  v_mfma_f32_16x16x32_bf16 v[80:83], a[0:3], v[128:131], 0
  s_mov_b32 s11, 0
  buffer_load_dword v240, v7, s[24:27], s11 offen sc1
  v_mfma_f32_16x16x32_bf16 v[84:87], a[4:7], v[128:131], 0
  s_mov_b32 s11, 8192
  buffer_load_dword v241, v7, s[24:27], s11 offen sc1
  v_mfma_f32_16x16x32_bf16 v[88:91], a[8:11], v[128:131], 0
  s_mov_b32 s11, 65536
  buffer_load_dword v242, v7, s[24:27], s11 offen sc1
  v_mfma_f32_16x16x32_bf16 v[92:95], a[12:15], v[128:131], 0
  s_mov_b32 s11, 73728
  buffer_load_dword v243, v7, s[24:27], s11 offen sc1
  v_mfma_f32_16x16x32_bf16 v[80:83], a[16:19], v[132:135], v[80:83]
  s_mov_b32 s11, 131072
  buffer_load_dword v244, v7, s[24:27], s11 offen sc1
  v_mfma_f32_16x16x32_bf16 v[84:87], a[20:23], v[132:135], v[84:87]
  s_add_u32 s3, s4, 3
  s_and_b32 s3, s3, 3
  s_mul_i32 s3, s3, 12288
  s_add_u32 s3, s3, 8192
  v_lshl_add_u32 v10, v1, 4, s3
  v_mfma_f32_16x16x32_bf16 v[88:91], a[24:27], v[132:135], v[88:91]
  s_mov_b32 s11, 139264
  buffer_load_dword v245, v7, s[24:27], s11 offen sc1
  v_mfma_f32_16x16x32_bf16 v[92:95], a[28:31], v[132:135], v[92:95]
  s_mov_b32 s11, 196608
  buffer_load_dword v246, v7, s[24:27], s11 offen sc1
  s_waitcnt vmcnt(28)
  v_mfma_f32_16x16x32_bf16 v[80:83], a[32:35], v[136:139], v[80:83]
  s_mov_b32 s11, 204800
  buffer_load_dword v247, v7, s[24:27], s11 offen sc1
  v_mfma_f32_16x16x32_bf16 v[84:87], a[36:39], v[136:139], v[84:87]
  ds_write_b128 v10, v[64:67] offset:0
  v_mfma_f32_16x16x32_bf16 v[88:91], a[40:43], v[136:139], v[88:91]
  v_mfma_f32_16x16x32_bf16 v[92:95], a[44:47], v[136:139], v[92:95]
  v_mfma_f32_16x16x32_bf16 v[80:83], a[48:51], v[140:143], v[80:83]
  v_mfma_f32_16x16x32_bf16 v[84:87], a[52:55], v[140:143], v[84:87]
  ds_write_b128 v10, v[68:71] offset:1024
  v_mfma_f32_16x16x32_bf16 v[88:91], a[56:59], v[140:143], v[88:91]
  v_mfma_f32_16x16x32_bf16 v[92:95], a[60:63], v[140:143], v[92:95]
  s_waitcnt vmcnt(19)
  v_mfma_f32_16x16x32_bf16 v[80:83], a[64:67], v[200:203], v[80:83]
  v_mfma_f32_16x16x32_bf16 v[84:87], a[68:71], v[200:203], v[84:87]
  ds_write_b128 v10, v[72:75] offset:2048
  v_mfma_f32_16x16x32_bf16 v[88:91], a[72:75], v[200:203], v[88:91]
  v_mfma_f32_16x16x32_bf16 v[92:95], a[76:79], v[200:203], v[92:95]
  v_mfma_f32_16x16x32_bf16 v[80:83], a[80:83], v[204:207], v[80:83]
  v_mfma_f32_16x16x32_bf16 v[84:87], a[84:87], v[204:207], v[84:87]
  ds_write_b128 v10, v[76:79] offset:3072
  v_mfma_f32_16x16x32_bf16 v[88:91], a[88:91], v[204:207], v[88:91]
  v_mfma_f32_16x16x32_bf16 v[92:95], a[92:95], v[204:207], v[92:95]
  s_waitcnt lgkmcnt(0)
  s_barrier
  s_mul_i32 s3, s4, 12288
  s_add_u32 s3, s3, 0
  v_lshl_add_u32 v10, v1, 4, s3
  s_waitcnt vmcnt(16)
  v_mfma_f32_16x16x32_bf16 v[80:83], a[96:99], v[208:211], v[80:83]
  ds_read_b128 v[96:99], v10 offset:0
  v_mfma_f32_16x16x32_bf16 v[84:87], a[100:103], v[208:211], v[84:87]
  ds_read_b128 v[100:103], v10 offset:1024
  v_mfma_f32_16x16x32_bf16 v[88:91], a[104:107], v[208:211], v[88:91]
  ds_read_b128 v[104:107], v10 offset:2048
  v_mfma_f32_16x16x32_bf16 v[92:95], a[108:111], v[208:211], v[92:95]
  ds_read_b128 v[108:111], v10 offset:3072
  v_mfma_f32_16x16x32_bf16 v[80:83], a[112:115], v[212:215], v[80:83]
  ds_read_b128 v[112:115], v10 offset:4096
  v_mfma_f32_16x16x32_bf16 v[84:87], a[116:119], v[212:215], v[84:87]
  ds_read_b128 v[116:119], v10 offset:5120
  v_mfma_f32_16x16x32_bf16 v[88:91], a[120:123], v[212:215], v[88:91]
  ds_read_b128 v[120:123], v10 offset:6144
  v_mfma_f32_16x16x32_bf16 v[92:95], a[124:127], v[212:215], v[92:95]
  ds_read_b128 v[124:127], v10 offset:7168
  s_waitcnt vmcnt(14)
  v_mfma_f32_16x16x32_bf16 v[80:83], a[128:131], v[216:219], v[80:83]
  ds_read_b128 v[144:147], v10 offset:8192
  v_mfma_f32_16x16x32_bf16 v[84:87], a[132:135], v[216:219], v[84:87]
  ds_read_b128 v[148:151], v10 offset:9216
  v_mfma_f32_16x16x32_bf16 v[88:91], a[136:139], v[216:219], v[88:91]
  ds_read_b128 v[152:155], v10 offset:10240
  v_mfma_f32_16x16x32_bf16 v[92:95], a[140:143], v[216:219], v[92:95]
  ds_read_b128 v[156:159], v10 offset:11264
  v_mfma_f32_16x16x32_bf16 v[80:83], a[144:147], v[220:223], v[80:83]
  v_mfma_f32_16x16x32_bf16 v[84:87], a[148:151], v[220:223], v[84:87]
  v_mfma_f32_16x16x32_bf16 v[88:91], a[152:155], v[220:223], v[88:91]
  v_mfma_f32_16x16x32_bf16 v[92:95], a[156:159], v[220:223], v[92:95]
  s_waitcnt vmcnt(12)
  v_mfma_f32_16x16x32_bf16 v[80:83], a[160:163], v[224:227], v[80:83]
  v_mfma_f32_16x16x32_bf16 v[84:87], a[164:167], v[224:227], v[84:87]
  v_mfma_f32_16x16x32_bf16 v[88:91], a[168:171], v[224:227], v[88:91]
  v_mfma_f32_16x16x32_bf16 v[92:95], a[172:175], v[224:227], v[92:95]
  v_mfma_f32_16x16x32_bf16 v[80:83], a[176:179], v[228:231], v[80:83]
  v_mfma_f32_16x16x32_bf16 v[84:87], a[180:183], v[228:231], v[84:87]
  v_mfma_f32_16x16x32_bf16 v[88:91], a[184:187], v[228:231], v[88:91]
  v_mfma_f32_16x16x32_bf16 v[92:95], a[188:191], v[228:231], v[92:95]
  s_waitcnt vmcnt(9)
  v_mfma_f32_16x16x32_bf16 v[80:83], a[192:195], v[232:235], v[80:83]
  v_mfma_f32_16x16x32_bf16 v[84:87], a[196:199], v[232:235], v[84:87]
  v_mfma_f32_16x16x32_bf16 v[88:91], a[200:203], v[232:235], v[88:91]
  v_mfma_f32_16x16x32_bf16 v[92:95], a[204:207], v[232:235], v[92:95]
  v_mfma_f32_16x16x32_bf16 v[80:83], a[208:211], v[236:239], v[80:83]
  v_mfma_f32_16x16x32_bf16 v[84:87], a[212:215], v[236:239], v[84:87]
  v_mfma_f32_16x16x32_bf16 v[88:91], a[216:219], v[236:239], v[88:91]
  v_mfma_f32_16x16x32_bf16 v[92:95], a[220:223], v[236:239], v[92:95]
  s_waitcnt lgkmcnt(0)
  s_nop 3
  v_pk_add_f32 v[80:81], v[80:81], v[96:97]
  v_pk_add_f32 v[82:83], v[82:83], v[98:99]
  v_pk_add_f32 v[84:85], v[84:85], v[100:101]
  v_pk_add_f32 v[86:87], v[86:87], v[102:103]
  v_pk_add_f32 v[88:89], v[88:89], v[104:105]
  v_pk_add_f32 v[90:91], v[90:91], v[106:107]
  v_pk_add_f32 v[92:93], v[92:93], v[108:109]
  v_pk_add_f32 v[94:95], v[94:95], v[110:111]
  v_pk_add_f32 v[80:81], v[80:81], v[112:113]
  v_pk_add_f32 v[82:83], v[82:83], v[114:115]
  v_pk_add_f32 v[84:85], v[84:85], v[116:117]
  v_pk_add_f32 v[86:87], v[86:87], v[118:119]
  v_pk_add_f32 v[88:89], v[88:89], v[120:121]
  v_pk_add_f32 v[90:91], v[90:91], v[122:123]
  v_pk_add_f32 v[92:93], v[92:93], v[124:125]
  v_pk_add_f32 v[94:95], v[94:95], v[126:127]
  v_pk_add_f32 v[80:81], v[80:81], v[144:145]
  v_pk_add_f32 v[82:83], v[82:83], v[146:147]
  v_pk_add_f32 v[84:85], v[84:85], v[148:149]
  v_pk_add_f32 v[86:87], v[86:87], v[150:151]
  v_pk_add_f32 v[88:89], v[88:89], v[152:153]
  v_pk_add_f32 v[90:91], v[90:91], v[154:155]
  v_pk_add_f32 v[92:93], v[92:93], v[156:157]
  v_pk_add_f32 v[94:95], v[94:95], v[158:159]
  v_and_b32 v8, 1, v3
  v_lshlrev_b32 v8, 5, v8
  v_lshrrev_b32 v9, 1, v3
  v_lshl_add_u32 v8, v9, 4, v8
  v_lshl_add_u32 v8, v4, 10, v8
  s_lshl_b32 s3, s9, 7
  v_fma_f32 v80, v11, v80, v12
  v_fma_f32 v81, v11, v81, v13
  v_fma_f32 v82, v11, v82, v14
  v_fma_f32 v83, v11, v83, v15
  v_fma_f32 v84, v11, v84, v16
  v_fma_f32 v85, v11, v85, v17
  v_fma_f32 v86, v11, v86, v18
  v_fma_f32 v87, v11, v87, v19
  v_fma_f32 v88, v11, v88, v20
  v_fma_f32 v89, v11, v89, v21
  v_fma_f32 v90, v11, v90, v22
  v_fma_f32 v91, v11, v91, v23
  v_fma_f32 v92, v11, v92, v24
  v_fma_f32 v93, v11, v93, v25
  v_fma_f32 v94, v11, v94, v26
  v_fma_f32 v95, v11, v95, v27
  s_waitcnt vmcnt(0)
  v_lshlrev_b32 v28, 16, v240
  v_and_b32 v29, 0xffff0000, v240
  v_fma_f32 v80, v31, v28, v80
  v_fma_f32 v81, v31, v29, v81
  v_cvt_pk_bf16_f32 v96, v80, v81
  v_lshlrev_b32 v28, 16, v241
  v_and_b32 v29, 0xffff0000, v241
  v_fma_f32 v82, v31, v28, v82
  v_fma_f32 v83, v31, v29, v83
  v_cvt_pk_bf16_f32 v97, v82, v83
  v_lshlrev_b32 v28, 16, v242
  v_and_b32 v29, 0xffff0000, v242
  v_fma_f32 v84, v31, v28, v84
  v_fma_f32 v85, v31, v29, v85
  v_cvt_pk_bf16_f32 v98, v84, v85
  v_lshlrev_b32 v28, 16, v243
  v_and_b32 v29, 0xffff0000, v243
  v_fma_f32 v86, v31, v28, v86
  v_fma_f32 v87, v31, v29, v87
  v_cvt_pk_bf16_f32 v99, v86, v87
  v_lshlrev_b32 v28, 16, v244
  v_and_b32 v29, 0xffff0000, v244
  v_fma_f32 v88, v31, v28, v88
  v_fma_f32 v89, v31, v29, v89
  v_cvt_pk_bf16_f32 v100, v88, v89
  v_lshlrev_b32 v28, 16, v245
  v_and_b32 v29, 0xffff0000, v245
  v_fma_f32 v90, v31, v28, v90
  v_fma_f32 v91, v31, v29, v91
  v_cvt_pk_bf16_f32 v101, v90, v91
  v_lshlrev_b32 v28, 16, v246
  v_and_b32 v29, 0xffff0000, v246
  v_fma_f32 v92, v31, v28, v92
  v_fma_f32 v93, v31, v29, v93
  v_cvt_pk_bf16_f32 v102, v92, v93
  v_lshlrev_b32 v28, 16, v247
  v_and_b32 v29, 0xffff0000, v247
  v_fma_f32 v94, v31, v28, v94
  v_fma_f32 v95, v31, v29, v95
  v_cvt_pk_bf16_f32 v103, v94, v95
  v_permlane16_swap_b32 v96, v98
  v_permlane16_swap_b32 v97, v99
  v_permlane16_swap_b32 v100, v102
  v_permlane16_swap_b32 v101, v103
  buffer_store_dwordx4 v[96:99], v8, s[28:31], s3 offen offset:0
  buffer_store_dwordx4 v[100:103], v8, s[28:31], s3 offen offset:64
  s_or_b32 s3, s2, s4
  s_cmp_lg_u32 s3, 0
  s_cbranch_scc1 L_noadvance
  v_mov_b32 v4, 0
  v_mov_b32 v5, s72
  buffer_store_dword v5, v4, s[24:27], 0 offen sc1
L_noadvance:
  s_waitcnt vmcnt(0) lgkmcnt(0)
L_end:
  s_endpgm
.p2align 6
L_gtab:
  .long 0x5000500, 0x5000500, 0x4fe04fe, 0x4fe04fe, 0x4fe04fe, 0x7d004fe
  .long 0x4fe04fe, 0x4fc04fe, 0x4fc04fc, 0x4fc04fc, 0x4fc04fc, 0x7d004fc
  .long 0x4fc04fc, 0x4fc04fc, 0x4fa04fa, 0x4fa04fa, 0x4fa04fa, 0x7d004fa
  .long 0x4fa04fa, 0x4f804fa, 0x4f804f8, 0x4f804f8, 0x4f804f8, 0x7d004f8
  .long 0x4f804f8, 0x4f804f8, 0x4f604f6, 0x4f604f6, 0x4f604f6, 0x7d004f6
  .long 0x4f604f6, 0x4f404f6, 0x4f404f4, 0x4f404f4, 0x4f404f4, 0x7d004f4
  .long 0x4f404f4, 0x4f404f4, 0x4f204f2, 0x4f204f2, 0x4f204f2, 0x7d004f2
  .long 0x4f204f2, 0x4f004f2, 0x4f004f0, 0x4f004f0, 0x4f004f0, 0x7d004f0
  .long 0x4f004f0, 0x4f004f0, 0x4ee04ee, 0x4ee04ee, 0x4ee04ee, 0x7d004ee
  .long 0x4ee04ee, 0x4ec04ee, 0x4ec04ec, 0x4ec04ec, 0x4ec04ec, 0x7d004ec
  .long 0x4ec04ec, 0x4ec04ec, 0x4ea04ea, 0x4ea04ea, 0x4ea04ea, 0x7d004ea
  .long 0x4ea04ea, 0x4e804ea, 0x4e804e8, 0x4e804e8, 0x4e804e8, 0x7d004e8
  .long 0x4e804e8, 0x4e804e8, 0x4e604e6, 0x4e604e6, 0x4e604e6, 0x7d004e6
  .long 0x4e604e6, 0x4e404e6, 0x4e404e4, 0x4e404e4, 0x4e404e4, 0x7d004e4
  .long 0x4e404e4, 0x4e404e4, 0x4e204e2, 0x4e204e2, 0x4e204e2, 0x7d004e2
  .long 0x4e204e2, 0x4e004e2, 0x4e004e0, 0x4e004e0, 0x4e004e0, 0x7d004e0
  .long 0x4e004e0, 0x4e004e0, 0x4de04de, 0x4de04de, 0x4de04de, 0x7d004de
  .long 0x4de04de, 0x4dc04de, 0x4dc04dc, 0x4dc04dc, 0x4dc04dc, 0x7d004dc
  .long 0x4dc04dc, 0x4dc04dc, 0x4da04da, 0x4da04da, 0x4da04da, 0x7d004da
  .long 0x4da04da, 0x4d804da, 0x4d804d8, 0x4d804d8, 0x4d804d8, 0x7d004d8
  .long 0x4d804d8, 0x4d804d8, 0x4d604d6, 0x4d604d6, 0x4d604d6, 0x7d004d6
  .long 0x4d604d6, 0x4d404d6, 0x4d404d4, 0x4d404d4, 0x4d404d4, 0x7d004d4
  .long 0x4d404d4, 0x4d404d4, 0x4d204d2, 0x4d204d2, 0x4d204d2, 0x7d004d2
  .long 0x4d204d2, 0x4d004d2, 0x4d004d0, 0x4d004d0, 0x4d004d0, 0x7d004d0
  .long 0x4d004d0, 0x4d004d0, 0x4ce04ce, 0x4ce04ce, 0x4ce04ce, 0x7d004ce
  .long 0x4ce04ce, 0x4cc04ce, 0x4cc04cc, 0x4cc04cc, 0x4cc04cc, 0x7d004cc
  .long 0x4cc04cc, 0x4cc04cc, 0x4ca04ca, 0x4ca04ca, 0x4ca04ca, 0x7d004ca
  .long 0x4ca04ca, 0x4c804ca, 0x4c804c8, 0x4c804c8, 0x4c804c8, 0x7d004c8
  .long 0x4c804c8, 0x4c804c8, 0x4c604c6, 0x4c604c6, 0x4c604c6, 0x7d004c6
  .long 0x4c604c6, 0x4c404c6, 0x4c404c4, 0x4c404c4, 0x4c404c4, 0x7d004c4
  .long 0x4c404c4, 0x4c404c4, 0x4c204c2, 0x4c204c2, 0x4c204c2, 0x7d004c2
  .long 0x4c204c2, 0x4c004c2, 0x4c004c0, 0x4c004c0, 0x4c004c0, 0x7d004c0
  .long 0x4c004c0, 0x4c004c0, 0x4be04be, 0x4be04be, 0x4be04be, 0x7d004be
  .long 0x4be04be, 0x4bc04be, 0x4bc04bc, 0x4bc04bc, 0x4bc04bc, 0x7d004bc
  .long 0x4bc04bc, 0x4bc04bc, 0x4ba04ba, 0x4ba04ba, 0x4ba04ba, 0x7d004ba
  .long 0x4ba04ba, 0x4b804ba, 0x4b804b8, 0x4b804b8, 0x4b804b8, 0x7d004b8
  .long 0x4b804b8, 0x4b804b8, 0x4b604b6, 0x4b604b6, 0x4b604b6, 0x7d004b6
  .long 0x4b604b6, 0x4b404b6, 0x4b404b4, 0x4b404b4, 0x4b404b4, 0x7d004b4
  .long 0x4b404b4, 0x4b404b4, 0x4b204b2, 0x4b204b2, 0x4b204b2, 0x7d004b2
  .long 0x4b204b2, 0x4b004b2, 0x4b004b0, 0x4b004b0, 0x4b004b0, 0x7d004b0
  .long 0x4b004b0, 0x4b004b0, 0x4ae04ae, 0x4ae04ae, 0x4ae04ae, 0x7d004ae
  .long 0x4ae04ae, 0x4ac04ae, 0x4ac04ac, 0x4ac04ac, 0x4ac04ac, 0x7d004ac
  .long 0x4ac04ac, 0x4ac04ac, 0x4aa04aa, 0x4aa04aa, 0x4aa04aa, 0x7d004aa
  .long 0x4aa04aa, 0x4a804aa, 0x4a804a8, 0x4a804a8, 0x4a804a8, 0x7d004a8
  .long 0x4a804a8, 0x4a804a8, 0x4a604a6, 0x4a604a6, 0x4a604a6, 0x7d004a6
  .long 0x4a604a6, 0x4a404a6, 0x4a404a4, 0x4a404a4, 0x4a404a4, 0x7d004a4
  .long 0x4a404a4, 0x4a404a4, 0x4a204a2, 0x4a204a2, 0x4a204a2, 0x7d004a2
  .long 0x4a204a2, 0x4a004a2, 0x4a004a0, 0x4a004a0, 0x4a004a0, 0x7d004a0
  .long 0x4a004a0, 0x4a004a0, 0x49e049e, 0x49e049e, 0x49e049e, 0x7d0049e
  .long 0x49e049e, 0x49c049e, 0x49c049c, 0x49c049c, 0x49c049c, 0x7d0049c
  .long 0x49c049c, 0x49c049c, 0x49a049a, 0x49a049a, 0x49a049a, 0x7d0049a
  .long 0x49a049a, 0x498049a, 0x4980498, 0x4980498, 0x4980498, 0x7d00498
  .long 0x4980498, 0x4980498, 0x4960496, 0x4960496, 0x4960496, 0x7d00496
  .long 0x4960496, 0x4940496, 0x4940494, 0x4940494, 0x4940494, 0x7d00494
  .long 0x4940494, 0x4940494, 0x4920492, 0x4920492, 0x4920492, 0x7d00492
  .long 0x4920492, 0x4900492, 0x4900490, 0x4900490, 0x4900490, 0x7d00490
  .long 0x4900490, 0x4900490, 0x48e048e, 0x48e048e, 0x48e048e, 0x7d0048e
  .long 0x48e048e, 0x48c048e, 0x48c048c, 0x48c048c, 0x48c048c, 0x7d0048c
  .long 0x48c048c, 0x48c048c, 0x48a048a, 0x48a048a, 0x48a048a, 0x7d0048a
  .long 0x48a048a, 0x488048a, 0x4880488, 0x4880488, 0x4880488, 0x7d00488
  .long 0x4880488, 0x4880488, 0x4860486, 0x4860486, 0x4860486, 0x7d00486
  .long 0x4860486, 0x4840486, 0x4840484, 0x4840484, 0x4840484, 0x7d00484
  .long 0x4840484, 0x4840484, 0x4820482, 0x4820482, 0x4820482, 0x7d00482
  .long 0x4820482, 0x4800482, 0x4800480, 0x4800480, 0x4800480, 0x7d00480
  .long 0x4800480, 0x4800480, 0x47e047e, 0x47e047e, 0x47e047e, 0x7d0047e
  .long 0x47e047e, 0x47c047e, 0x47c047c, 0x47c047c, 0x47c047c, 0x7d0047c
  .long 0x47c047c, 0x47c047c, 0x47a047a, 0x47a047a, 0x47a047a, 0x7d0047a
  .long 0x47a047a, 0x478047a, 0x4780478, 0x4780478, 0x4780478, 0x7d00478
  .long 0x4780478, 0x4780478, 0x4760476, 0x4760476, 0x4760476, 0x7d00476
  .long 0x4760476, 0x4740476, 0x4740474, 0x4740474, 0x4740474, 0x7d00474
  .long 0x4740474, 0x4740474, 0x4720472, 0x4720472, 0x4720472, 0x7d00472
  .long 0x4720472, 0x4700472, 0x4700470, 0x4700470, 0x4700470, 0x7d00470
  .long 0x4700470, 0x4700470, 0x46e046e, 0x46e046e, 0x46e046e, 0x7d0046e
  .long 0x46e046e, 0x46c046e, 0x46c046c, 0x46c046c, 0x46c046c, 0x7d0046c
  .long 0x46c046c, 0x46c046c, 0x46a046a, 0x46a046a, 0x46a046a, 0x7d0046a
  .long 0x46a046a, 0x468046a, 0x4680468, 0x4680468, 0x4680468, 0x7d00468
  .long 0x4680468, 0x4680468, 0x4660466, 0x4660466, 0x4660466, 0x7d00466
  .long 0x4660466, 0x4640466, 0x4640464, 0x4640464, 0x4640464, 0x7d00464
  .long 0x4640464, 0x4640464, 0x4620462, 0x4620462, 0x4620462, 0x7d00462
  .long 0x4620462, 0x4600462, 0x4600460, 0x4600460, 0x4600460, 0x7d00460
  .long 0x4600460, 0x4600460, 0x45e045e, 0x45e045e, 0x45e045e, 0x7d0045e
  .long 0x45e045e, 0x45c045e, 0x45c045c, 0x45c045c, 0x45c045c, 0x7d0045c
  .long 0x45c045c, 0x45c045c, 0x45a045a, 0x45a045a, 0x45a045a, 0x7d0045a
  .long 0x45a045a, 0x458045a, 0x4580458, 0x4580458, 0x4580458, 0x7d00458
  .long 0x4580458, 0x4580458, 0x4560456, 0x4560456, 0x4560456, 0x7d00456
  .long 0x4560456, 0x4540456, 0x4540454, 0x4540454, 0x4540454, 0x7d00454
  .long 0x4540454, 0x4540454, 0x4520452, 0x4520452, 0x4520452, 0x7d00452
  .long 0x4520452, 0x4500452, 0x4500450, 0x4500450, 0x4500450, 0x7d00450
  .long 0x4500450, 0x4500450, 0x44e044e, 0x44e044e, 0x44e044e, 0x7d0044e
  .long 0x44e044e, 0x44c044e, 0x44c044c, 0x44c044c, 0x44c044c, 0x7d0044c
  .long 0x44c044c, 0x44c044c, 0x44a044a, 0x44a044a, 0x44a044a, 0x7d0044a
  .long 0x44a044a, 0x448044a, 0x4480448, 0x4480448, 0x4480448, 0x7d00448
  .long 0x4480448, 0x4480448, 0x4460446, 0x4460446, 0x4460446, 0x7d00446
  .long 0x4460446, 0x4440446, 0x4440444, 0x4440444, 0x4440444, 0x7d00444
  .long 0x4440444, 0x4440444, 0x4420442, 0x4420442, 0x4420442, 0x7d00442
  .long 0x4420442, 0x4400442, 0x4400440, 0x4400440, 0x4400440, 0x7d00440
  .long 0x4400440, 0x4400440, 0x43e043e, 0x43e043e, 0x43e043e, 0x7d0043e
  .long 0x43e043e, 0x43c043e, 0x43c043c, 0x43c043c, 0x43c043c, 0x7d0043c
  .long 0x43c043c, 0x43c043c, 0x43a043a, 0x43a043a, 0x43a043a, 0x7d0043a
  .long 0x43a043a, 0x438043a, 0x4380438, 0x4380438, 0x4380438, 0x7d00438
  .long 0x4380438, 0x4380438, 0x4360436, 0x4360436, 0x4360436, 0x7d00436
  .long 0x4360436, 0x4340436, 0x4340434, 0x4340434, 0x4340434, 0x7d00434
  .long 0x4340434, 0x4340434, 0x4320432, 0x4320432, 0x4320432, 0x7d00432
  .long 0x4320432, 0x4300432, 0x4300430, 0x4300430, 0x4300430, 0x7d00430
  .long 0x4300430, 0x4300430, 0x42e042e, 0x42e042e, 0x42e042e, 0x7d0042e
  .long 0x42e042e, 0x42c042e, 0x42c042c, 0x42c042c, 0x42c042c, 0x7d0042c
  .long 0x42c042c, 0x42c042c, 0x42a042a, 0x42a042a, 0x42a042a, 0x7d0042a
  .long 0x42a042a, 0x428042a, 0x4280428, 0x4280428, 0x4280428, 0x7d00428
  .long 0x4280428, 0x4280428, 0x4260426, 0x4260426, 0x4260426, 0x7d00426
  .long 0x4260426, 0x4240426, 0x4240424, 0x4240424, 0x4240424, 0x7d00424
  .long 0x4240424, 0x4240424, 0x4220422, 0x4220422, 0x4220422, 0x7d00422
  .long 0x4220422, 0x4200422, 0x4200420, 0x4200420, 0x4200420, 0x7d00420
  .long 0x4200420, 0x4200420, 0x41e041e, 0x41e041e, 0x41e041e, 0x7d0041e
  .long 0x41e041e, 0x41c041e, 0x41c041c, 0x41c041c, 0x41c041c, 0x7d0041c
  .long 0x41c041c, 0x41c041c, 0x41a041a, 0x41a041a, 0x41a041a, 0x7d0041a
  .long 0x41a041a, 0x418041a, 0x4180418, 0x4180418, 0x4180418, 0x7d00418
  .long 0x4180418, 0x4180418, 0x4160416, 0x4160416, 0x4160416, 0x7d00416
  .long 0x4160416, 0x4140416, 0x4140414, 0x4140414, 0x4140414, 0x7d00414
  .long 0x4140414, 0x4140414, 0x4120412, 0x4120412, 0x4120412, 0x7d00412
  .long 0x4120412, 0x4100412, 0x4100410, 0x4100410, 0x4100410, 0x7d00410
  .long 0x4100410, 0x4100410, 0x40e040e, 0x40e040e, 0x40e040e, 0x7d0040e
  .long 0x40e040e, 0x40c040e, 0x40c040c, 0x40c040c, 0x40c040c, 0x7d0040c
  .long 0x40c040c, 0x40c040c, 0x40a040a, 0x40a040a, 0x40a040a, 0x7d0040a
  .long 0x40a040a, 0x408040a, 0x4080408, 0x4080408, 0x4080408, 0x7d00408
  .long 0x4080408, 0x4080408, 0x4060406, 0x4060406, 0x4060406, 0x7d00406
  .long 0x4060406, 0x4040406, 0x4040404, 0x4040404, 0x4040404, 0x7d00404
  .long 0x4040404, 0x4040404, 0x4020402, 0x4020402, 0x4020402, 0x7d00402
  .long 0x4020402, 0x4000402, 0x4000400, 0x4000400, 0x4000400, 0x7d003fe
  .long 0x4000400, 0x3fe03fe, 0x3fc03fe, 0x3fc03fc, 0x3fc03fc, 0x7d003fa
  .long 0x3fc03fc, 0x3fa03fa, 0x3f803fa, 0x3f803f8, 0x3f803f8, 0x7d003f6
  .long 0x3f803f8, 0x3f603f6, 0x3f403f6, 0x3f403f4, 0x3f403f4, 0x7d003f2
  .long 0x3f403f4, 0x3f203f2, 0x3f003f2, 0x3f003f0, 0x3f003f0, 0x7d003ee
  .long 0x3f003f0, 0x3ee03ee, 0x3ec03ee, 0x3ec03ec, 0x3ec03ec, 0x7d003ea
  .long 0x3ec03ec, 0x3ea03ea, 0x3e803ea, 0x3e803e8, 0x3e803e8, 0x7d003e6
  .long 0x3e803e8, 0x3e603e6, 0x3e403e6, 0x3e403e4, 0x3e403e4, 0x7d003e2
  .long 0x3e403e4, 0x3e203e2, 0x3e003e2, 0x3e003e0, 0x3e003e0, 0x7d003de
  .long 0x3e003e0, 0x3de03de, 0x3dc03de, 0x3dc03dc, 0x3dc03dc, 0x7d003da
  .long 0x3dc03dc, 0x3da03da, 0x3d803da, 0x3d803d8, 0x3d803d8, 0x7d003d6
  .long 0x3d803d8, 0x3d603d6, 0x3d403d6, 0x3d403d4, 0x3d403d4, 0x7d003d2
  .long 0x3d403d4, 0x3d203d2, 0x3d003d2, 0x3d003d0, 0x3d003d0, 0x7d003ce
  .long 0x3d003d0, 0x3ce03ce, 0x3cc03ce, 0x3cc03cc, 0x3cc03cc, 0x7d003ca
  .long 0x3cc03cc, 0x3ca03ca, 0x3c803ca, 0x3c803c8, 0x3c803c8, 0x7d003c6
  .long 0x3c803c8, 0x3c603c6, 0x3c403c6, 0x3c403c4, 0x3c403c4, 0x7d003c2
  .long 0x3c403c4, 0x3c203c2, 0x3c003c2, 0x3c003c0, 0x3c003c0, 0x7d003be
  .long 0x3c003c0, 0x3be03be, 0x3bc03be, 0x3bc03bc, 0x3bc03bc, 0x7d003ba
  .long 0x3bc03bc, 0x3ba03ba, 0x3b803ba, 0x3b803b8, 0x3b803b8, 0x7d003b6
  .long 0x3b803b8, 0x3b603b6, 0x3b403b6, 0x3b403b4, 0x3b403b4, 0x7d003b2
  .long 0x3b403b4, 0x3b203b2, 0x3b003b2, 0x3b003b0, 0x3b003b0, 0x7d003ae
  .long 0x3b003b0, 0x3ae03ae, 0x3ac03ae, 0x3ac03ac, 0x3ac03ac, 0x7d003aa
  .long 0x3ac03ac, 0x3aa03aa, 0x3a803aa, 0x3a803a8, 0x3a803a8, 0x7d003a6
  .long 0x3a803a8, 0x3a603a6, 0x3a403a6, 0x3a403a4, 0x3a403a4, 0x7d003a2
  .long 0x3a403a4, 0x3a203a2, 0x3a003a2, 0x3a003a0, 0x3a003a0, 0x7d0039e
  .long 0x3a003a0, 0x39e039e, 0x39c039e, 0x39c039c, 0x39c039c, 0x7d0039a
  .long 0x39c039c, 0x39a039a, 0x398039a, 0x3980398, 0x3980398, 0x7d00396
  .long 0x3980398, 0x3960396, 0x3940396, 0x3940394, 0x3940394, 0x7d00392
  .long 0x3940394, 0x3920392, 0x3900392, 0x3900390, 0x3900390, 0x7d0038e
  .long 0x3900390, 0x38e038e, 0x38c038e, 0x38c038c, 0x38c038c, 0x7d0038a
  .long 0x38c038c, 0x38a038a, 0x388038a, 0x3880388, 0x3880388, 0x7d00386
  .long 0x3880388, 0x3860386, 0x3840386, 0x3840384, 0x3840384, 0x7d00382
  .long 0x3840384, 0x3820382, 0x3800382, 0x3800380, 0x3800380, 0x7d0037e
  .long 0x3800380, 0x37e037e, 0x37c037e, 0x37c037c, 0x37c037c, 0x7d0037a
  .long 0x37c037c, 0x37a037a, 0x378037a, 0x3780378, 0x3780378, 0x7d00376
  .long 0x3780378, 0x3760376, 0x3740376, 0x3740374, 0x3740374, 0x7d00372
  .long 0x3740374, 0x3720372, 0x3700372, 0x3700370, 0x3700370, 0x7d0036e
  .long 0x3700370, 0x36e036e, 0x36c036e, 0x36c036c, 0x36c036c, 0x7d0036a
  .long 0x36c036c, 0x36a036a, 0x368036a, 0x3680368, 0x3680368, 0x7d00366
  .long 0x3680368, 0x3660366, 0x3640366, 0x3640364, 0x3640364, 0x7d00362
  .long 0x3640364, 0x3620362, 0x3600362, 0x3600360, 0x3600360, 0x7d0035e
  .long 0x3600360, 0x35e035e, 0x35c035e, 0x35c035c, 0x35c035c, 0x7d0035a
  .long 0x35c035c, 0x35a035a, 0x358035a, 0x3580358, 0x3580358, 0x7d00356
  .long 0x3580358, 0x3560356, 0x3540356, 0x3540354, 0x3540354, 0x7d00352
  .long 0x3540354, 0x3520352, 0x3500352, 0x3500350, 0x3500350, 0x7d0034e
  .long 0x3500350, 0x34e034e, 0x34c034e, 0x34c034c, 0x34c034c, 0x7d0034a
  .long 0x34c034c, 0x34a034a, 0x348034a, 0x3480348, 0x3480348, 0x7d00346
  .long 0x3480348, 0x3460346, 0x3440346, 0x3440344, 0x3440344, 0x7d00342
  .long 0x3440344, 0x3420342, 0x3400342, 0x3400340, 0x3400340, 0x7d0033e
  .long 0x3400340, 0x33e033e, 0x33c033e, 0x33c033c, 0x33c033c, 0x7d0033a
  .long 0x33c033c, 0x33a033a, 0x338033a, 0x3380338, 0x3380338, 0x7d00336
  .long 0x3380338, 0x3360336, 0x3340336, 0x3340334, 0x3340334, 0x7d00332
  .long 0x3340334, 0x3320332, 0x3300332, 0x3300330, 0x3300330, 0x7d0032e
  .long 0x3300330, 0x32e032e, 0x32c032e, 0x32c032c, 0x32c032c, 0x7d0032a
  .long 0x32c032c, 0x32a032a, 0x328032a, 0x3280328, 0x3280328, 0x7d00326
  .long 0x3280328, 0x3260326, 0x3240326, 0x3240324, 0x3240324, 0x7d00322
  .long 0x3240324, 0x3220322, 0x3200322, 0x3200320, 0x3200320, 0x7d0031e
  .long 0x3200320, 0x31e031e, 0x31c031e, 0x31c031c, 0x31c031c, 0x7d0031a
  .long 0x31c031c, 0x31a031a, 0x318031a, 0x3180318, 0x3180318, 0x7d00316
  .long 0x3180318, 0x3160316, 0x3140316, 0x3140314, 0x3140314, 0x7d00312
  .long 0x3140314, 0x3120312, 0x3100312, 0x3100310, 0x3100310, 0x7d0030e
  .long 0x3100310, 0x30e030e, 0x30c030e, 0x30c030c, 0x30c030c, 0x7d0030a
  .long 0x30c030c, 0x30a030a, 0x308030a, 0x3080308, 0x3080308, 0x7d00306
  .long 0x3080308, 0x3060306, 0x3040306, 0x3040304, 0x3040304, 0x7d00302
  .long 0x3040304, 0x3020302, 0x3000302, 0x3000300, 0x2fe0300, 0x7d002fc
  .long 0x2fe0300, 0x2fc02fc, 0x2fa02fc, 0x2f802f8, 0x2f602f8, 0x7d002f4
  .long 0x2f602f8, 0x2f402f4, 0x2f202f4, 0x2f002f0, 0x2ee02f0, 0x7d002ec
  .long 0x2ee02f0, 0x2ec02ec, 0x2ea02ec, 0x2e802e8, 0x2e602e8, 0x7d002e4
  .long 0x2e602e8, 0x2e402e4, 0x2e202e4, 0x2e002e0, 0x2de02e0, 0x7d002dc
  .long 0x2de02e0, 0x2dc02dc, 0x2da02dc, 0x2d802d8, 0x2d602d8, 0x7d002d4
  .long 0x2d602d8, 0x2d402d4, 0x2d202d4, 0x2d002d0, 0x2ce02d0, 0x7d002cc
  .long 0x2ce02d0, 0x2cc02cc, 0x2ca02cc, 0x2c802c8, 0x2c602c8, 0x7d002c4
  .long 0x2c602c8, 0x2c402c4, 0x2c202c4, 0x2c002c0, 0x2be02c0, 0x7d002bc
  .long 0x2be02c0, 0x2bc02bc, 0x2ba02bc, 0x2b802b8, 0x2b602b8, 0x7d002b4
  .long 0x2b602b8, 0x2b402b4, 0x2b202b4, 0x2b002b0, 0x2ae02b0, 0x7d002ac
  .long 0x2ae02b0, 0x2ac02ac, 0x2aa02ac, 0x2a802a8, 0x2a602a8, 0x7d002a4
  .long 0x2a602a8, 0x2a402a4, 0x2a202a4, 0x2a002a0, 0x29e02a0, 0x7d0029c
  .long 0x29e02a0, 0x29c029c, 0x29a029c, 0x2980298, 0x2960298, 0x7d00294
  .long 0x2960298, 0x2940294, 0x2920294, 0x2900290, 0x28e0290, 0x7d0028c
  .long 0x28e0290, 0x28c028c, 0x28a028c, 0x2880288, 0x2860288, 0x7d00284
  .long 0x2860288, 0x2840284, 0x2820284, 0x2800280, 0x27e0280, 0x7d0027c
  .long 0x27e0280, 0x27c027c, 0x27a027c, 0x2780278, 0x2760278, 0x7d00274
  .long 0x2760278, 0x2740274, 0x2720274, 0x2700270, 0x26e0270, 0x7d0026c
  .long 0x26e0270, 0x26c026c, 0x26a026c, 0x2680268, 0x2660268, 0x7d00264
  .long 0x2660268, 0x2640264, 0x2620264, 0x2600260, 0x25e0260, 0x7d0025c
  .long 0x25e0260, 0x25c025c, 0x25a025c, 0x2580258, 0x2560258, 0x7d00254
  .long 0x2560258, 0x2540254, 0x2520254, 0x2500250, 0x24e0250, 0x7d0024c
  .long 0x24e0250, 0x24c024c, 0x24a024c, 0x2480248, 0x2460248, 0x7d00244
  .long 0x2460248, 0x2440244, 0x2420244, 0x2400240, 0x23e0240, 0x7d0023c
  .long 0x23e0240, 0x23c023c, 0x23a023c, 0x2380238, 0x2360238, 0x7d00234
  .long 0x2360238, 0x2340234, 0x2320234, 0x2300230, 0x22e0230, 0x7d0022c
  .long 0x22e0230, 0x22c022c, 0x22a022c, 0x2280228, 0x2260228, 0x7d00224
  .long 0x2260228, 0x2240224, 0x2220224, 0x2200220, 0x21e0220, 0x7d0021c
  .long 0x21e0220, 0x21c021c, 0x21a021c, 0x2180218, 0x2160218, 0x7d00214
  .long 0x2160218, 0x2140214, 0x2120214, 0x2100210, 0x20e0210, 0x7d0020c
  .long 0x20e0210, 0x20c020c, 0x20a020c, 0x2080208, 0x2060208, 0x7d00204
  .long 0x2060208, 0x2040204, 0x2020204, 0x2000200, 0x1fc01fe, 0x7d001fa
  .long 0x1fc01fe, 0x1f801fa, 0x1f401f6, 0x1f001f2, 0x1ec01ee, 0x7d001ea
  .long 0x1ec01ee, 0x1e801ea, 0x1e401e6, 0x1e001e2, 0x1dc01de, 0x7d001da
  .long 0x1dc01de, 0x1d801da, 0x1d401d6, 0x1d001d2, 0x1cc01ce, 0x7d001ca
  .long 0x1cc01ce, 0x1c801ca, 0x1c401c6, 0x1c001c2, 0x1bc01be, 0x7d001ba
  .long 0x1bc01be, 0x1b801ba, 0x1b401b6, 0x1b001b2, 0x1ac01ae, 0x7d001aa
  .long 0x1ac01ae, 0x1a801aa, 0x1a401a6, 0x1a001a2, 0x19c019e, 0x7d0019a
  .long 0x19c019e, 0x198019a, 0x1940196, 0x1900192, 0x18c018e, 0x7d0018a
  .long 0x18c018e, 0x188018a, 0x1840186, 0x1800182, 0x17c017e, 0x7d0017a
  .long 0x17c017e, 0x178017a, 0x1740176, 0x1700172, 0x16c016e, 0x7d0016a
  .long 0x16c016e, 0x168016a, 0x1640166, 0x1600162, 0x15c015e, 0x7d0015a
  .long 0x15c015e, 0x158015a, 0x1540156, 0x1500152, 0x14c014e, 0x7d0014a
  .long 0x14c014e, 0x148014a, 0x1440146, 0x1400142, 0x13c013e, 0x7d0013a
  .long 0x13c013e, 0x138013a, 0x1340136, 0x1300132, 0x12c012e, 0x7d0012a
  .long 0x12c012e, 0x128012a, 0x1240126, 0x1200122, 0x11c011e, 0x7d0011a
  .long 0x11c011e, 0x118011a, 0x1140116, 0x1100112, 0x10c010e, 0x7d0010a
  .long 0x10c010e, 0x108010a, 0x1040106, 0x1000102, 0xfc00fe, 0x7d000fa
  .long 0xfc00fe, 0xf800fa, 0xf400f6, 0xf000f2, 0xec00ee, 0x7d000ea
  .long 0xec00ee, 0xe800ea, 0xe400e6, 0xe000e2, 0xdc00de, 0x7d000da
  .long 0xdc00de, 0xd800da, 0xd400d6, 0xd000d2, 0xcc00ce, 0x7d000ca
  .long 0xcc00ce, 0xc800ca, 0xc400c6, 0xc000c2, 0xbc00be, 0x7d000ba
  .long 0xbc00be, 0xb800ba, 0xb400b6, 0xb000b2, 0xac00ae, 0x7d000aa
  .long 0xac00ae, 0xa800aa, 0xa400a6, 0xa000a2, 0x9c009e, 0x7d0009a
  .long 0x9c009e, 0x98009a, 0x940096, 0x900092, 0x8c008e, 0x7d0008a
  .long 0x8c008e, 0x88008a, 0x840086, 0x800082, 0x7c007e, 0x7d0007a
  .long 0x7c007e, 0x78007a, 0x740076, 0x700072, 0x6c006e, 0x7d0006a
  .long 0x6c006e, 0x68006a, 0x640066, 0x600062, 0x5c005e, 0x7d0005a
  .long 0x5c005e, 0x58005a, 0x540056, 0x500052, 0x4c004e, 0x7d0004a
  .long 0x4c004e, 0x48004a, 0x440046, 0x400042, 0x3c003e, 0x7d0003a
  .long 0x3c003e, 0x38003a, 0x340036, 0x300032, 0x2c002e, 0x7d0002a
  .long 0x2c002e, 0x28002a, 0x240026, 0x200022, 0x1c001e, 0x7d0001a
  .long 0x1c001e, 0x18001a, 0x140016, 0x100012, 0xc000e, 0x7d0000a
  .long 0xc000e, 0x8000a, 0x40006, 0x2, 0x7d007d0, 0x7d007d0
L_gend:
.section .rodata,"a"
.p2align 6
.amdhsa_kernel gated_mix__ssm_conv_s4__mixer_channel_mlp__prompt_kernel
  .amdhsa_next_free_vgpr 512
  .amdhsa_next_free_sgpr 102
  .amdhsa_accum_offset 256
  .amdhsa_group_segment_fixed_size 0
  .amdhsa_kernarg_size 144
  .amdhsa_user_sgpr_count 2
  .amdhsa_user_sgpr_kernarg_segment_ptr 1
  .amdhsa_system_sgpr_workgroup_id_x 1
.end_amdhsa_kernel
```
